```python
import torch

def _softmax(x, axis=-1):
    return torch.softmax(x, dim=axis)
def _gelu(x):
    return torch.nn.functional.gelu(x, approximate="tanh")
def _silu(x):
    return torch.nn.functional.silu(x)
def _sigmoid(x):
    return torch.sigmoid(x)
def _layernorm(x, axis=-1, eps=1e-5):
    m = x.mean(dim=axis, keepdim=True)
    v = x.var(dim=axis, keepdim=True, unbiased=False)
    return (x - m) / torch.sqrt(v + eps)
def _scatter_add(tgt, idx, src, axis=0):
    return tgt.clone().index_add_(axis, idx, src)
def _segment_sum(src, seg, n):
    out = torch.zeros((n,) + src.shape[1:], dtype=src.dtype)
    return out.index_add_(0, seg, src)
def _pad(x, pw):
    flat = tuple(v for pair in reversed(pw) for v in pair)
    return torch.nn.functional.pad(x, flat)

kernel_name = 'gated_mix__softmax_full_mha__ssm_conv_h3__prompt'

def setup_inputs():

    _w = (lambda a: (lambda t: t.to(torch.bfloat16) if t.is_floating_point() else t)(torch.as_tensor(a)))
    def _A_setup():
        B, S, D = 1, 2048, 448
        return {
            "x": _w((lambda *s: torch.randn(*s, dtype=torch.bfloat16) * 0.05)(B, S, D)),
            "wqkv": _w((lambda *s: torch.randn(*s, dtype=torch.bfloat16) * 0.8)(D, 3 * D)),
            "wo": _w((lambda *s: torch.randn(*s, dtype=torch.bfloat16) * 0.05)(D, D)),
        }
    _A_in = _A_setup()

    def _B_setup():
        B, S, D = 1, 2048, 448
        ks = 4
        return {
            "q": _w((lambda *s: torch.randn(*s, dtype=torch.bfloat16) * 0.05)(B, S, D)),
            "k": _w((lambda *s: torch.randn(*s, dtype=torch.bfloat16) * 0.4)(B, S, D)),
            "v": _w((lambda *s: torch.randn(*s, dtype=torch.bfloat16) * 0.4)(B, S, D)),
            "shift_k": _w((lambda *s: torch.randn(*s, dtype=torch.bfloat16) * 0.4)(D, ks) * 0.5),
            "ssm_k": _w((lambda *s: torch.randn(*s, dtype=torch.bfloat16) * 0.8)(D, S) * (1.0 / S ** 0.5)),
            "ssm_D": _w((lambda *s: torch.randn(*s, dtype=torch.bfloat16) * 0.4)(D)),
        }
    _B_in = _B_setup()

    return {
        "A_x": _A_in["x"],
        "A_wqkv": _A_in["wqkv"],
        "A_wo": _A_in["wo"],
        "B_q": _B_in["q"],
        "B_k": _B_in["k"],
        "B_v": _B_in["v"],
        "B_shift_k": _B_in["shift_k"],
        "B_ssm_k": _B_in["ssm_k"],
        "B_ssm_D": _B_in["ssm_D"],
        "gate_w": _w((lambda *s: torch.randn(*s, dtype=torch.bfloat16) * 0.05)(448) * 16.0),
    }

def reference(A_x, A_wqkv, A_wo, B_q, B_k, B_v, B_shift_k, B_ssm_k, B_ssm_D, gate_w):
    def _A_ref(x, wqkv, wo):
        B, S, D = x.shape
        H = 16; Dh = D // H
        qkv = (lambda x, *d: x.permute(*d))((x @ wqkv).reshape(B, S, 3, H, Dh), 2, 0, 3, 1, 4)
        q, k, v = qkv[0], qkv[1], qkv[2]
        scale = Dh ** -0.5
        scores = torch.einsum("bhqd,bhkd->bhqk", q, k) * scale
        p = _softmax(scores, axis=-1)
        o = torch.einsum("bhqk,bhkd->bhqd", p, v)
        return (lambda x, *d: x.permute(*d))(o, 0, 2, 1, 3).reshape(B, S, D) @ wo

    def _B_ref(q, k, v, shift_k, ssm_k, ssm_D):
        B, S, D = q.shape
        ks = shift_k.shape[-1]
        k_pad = _pad(k, ((0, 0), (ks - 1, 0), (0, 0)))
        k_shift = torch.zeros_like(k)
        for t in range(ks):
            k_shift = k_shift + k_pad[:, t:t + S, :] * shift_k[:, ks - 1 - t][None, None, :]
        kv = k_shift * v
        L = 2 * S
        kv_pad = _pad(kv, ((0, 0), (0, S), (0, 0)))
        kf_pad = _pad(ssm_k, ((0, 0), (0, S)))
        kv_f = (lambda x, axes=(-2,-1): torch.fft.rfft2(x.float(), dim=axes))(kv_pad[:, None, :, :], axes=(1, 2))
        kf_f = (lambda x, axes=(-2,-1): torch.fft.rfft2(x.float(), dim=axes))(kf_pad[:, None, :], axes=(1, 2))
        kf_f = (lambda x, *d: x.permute(*d))(kf_f, 1, 2, 0)
        y_f = kv_f * kf_f[None, :, :, :]
        y = (lambda x, s, axes=(-2,-1): torch.fft.irfft2(x, s=s, dim=axes).to(torch.bfloat16))(y_f, (1, L), axes=(1, 2))[:, 0, :S, :]
        y = y + kv * ssm_D[None, None, :]
        return q * y

    x = A_x
    g = _sigmoid((x * gate_w).sum(-1, keepdims=True))
    a = _A_ref(x, A_wqkv, A_wo)
    b = _B_ref(x, B_k, B_v, B_shift_k, B_ssm_k, B_ssm_D)
    return g * a + (1 - g) * b
```

```asm
; @launch grid=(256,1,1) block=(512,1,1) lds=163840
.amdgcn_target "amdgcn-amd-amdhsa--gfx950"
.text
.globl gated_mix__softmax_full_mha__ssm_conv_h3__prompt_kernel
.p2align 8
.type gated_mix__softmax_full_mha__ssm_conv_h3__prompt_kernel,@function
gated_mix__softmax_full_mha__ssm_conv_h3__prompt_kernel:
s_cmp_ge_u32 s2, 256
s_cbranch_scc1 gated_mix__softmax_full_mha__ssm_conv_h3__prompt_kernel_end
s_load_dwordx16 s[36:51], s[0:1], 0
s_load_dwordx8 s[52:59], s[0:1], 64
s_load_dwordx2 s[60:61], s[0:1], 96
v_lshrrev_b32 v1, 6, v0
v_and_b32 v0, 63, v0
v_readfirstlane_b32 s4, v1
s_and_b32 s3, s2, 7
s_lshr_b32 s7, s2, 3
s_add_u32 s7, s7, 24
s_and_b32 s7, s7, 31
s_mov_b32 s71, 0
s_cmp_lg_u32 s4, 3
s_cbranch_scc1 gated_mix__softmax_full_mha__ssm_conv_h3__prompt_kernel_nopf
s_cmp_ge_u32 s7, 24
s_cbranch_scc1 gated_mix__softmax_full_mha__ssm_conv_h3__prompt_kernel_nopf
s_lshr_b32 s24, s3, 1
s_mul_i32 s24, s24, 458752
s_mul_i32 s25, s7, 22
v_min_u32 v20, 21, v0
v_add_u32 v20, s25, v20
v_min_u32 v20, 511, v20
v_mul_u32_u24 v20, 896, v20
v_min_u32 v21, 32, v0
v_mul_u32_u24 v26, 373, v21
v_lshrrev_b32 v26, 12, v26
v_mul_u32_u24 v25, 11, v26
v_sub_u32 v25, v21, v25
s_mul_i32 s25, s7, 3
v_add_u32 v26, s25, v26
v_min_u32 v26, 63, v26
v_mul_u32_u24 v26, 2688, v26
v_lshl_add_u32 v26, v25, 7, v26
s_and_b32 s25, s3, 1
s_mul_i32 s25, s25, 1280
s_waitcnt lgkmcnt(0)
s_mov_b32 s65, 14680064
s_load_dword s64, s[60:61], s65
s_mov_b64 s[8:9], s[36:37]
s_mov_b32 s10, 0x1c0000
s_mov_b32 s11, 0x20000
s_mov_b64 s[12:13], s[38:39]
s_mov_b32 s14, 0x126000
s_mov_b32 s15, 0x20000
s_mov_b64 s[16:17], s[60:61]
s_mov_b32 s18, 0x10000000
s_mov_b32 s19, 0x20000
v_cmp_gt_u32 vcc, 33, v0
s_and_saveexec_b64 s[34:35], vcc
s_add_u32 s27, s24, 0
buffer_load_dword v15, v20, s[8:11], s27 offen
s_add_u32 s26, s25, 0
buffer_load_dword v15, v26, s[12:15], s26 offen
s_add_u32 s27, s24, 128
buffer_load_dword v15, v20, s[8:11], s27 offen
s_add_u32 s26, s25, 172032
buffer_load_dword v15, v26, s[12:15], s26 offen
s_add_u32 s27, s24, 256
buffer_load_dword v15, v20, s[8:11], s27 offen
s_add_u32 s26, s25, 344064
buffer_load_dword v15, v26, s[12:15], s26 offen
s_add_u32 s27, s24, 384
buffer_load_dword v15, v20, s[8:11], s27 offen
s_add_u32 s26, s25, 516096
buffer_load_dword v15, v26, s[12:15], s26 offen
s_add_u32 s27, s24, 512
buffer_load_dword v15, v20, s[8:11], s27 offen
s_add_u32 s26, s25, 688128
buffer_load_dword v15, v26, s[12:15], s26 offen
s_add_u32 s27, s24, 640
buffer_load_dword v15, v20, s[8:11], s27 offen
s_add_u32 s26, s25, 860160
buffer_load_dword v15, v26, s[12:15], s26 offen
s_add_u32 s27, s24, 768
buffer_load_dword v15, v20, s[8:11], s27 offen
s_add_u32 s26, s25, 1032192
buffer_load_dword v15, v26, s[12:15], s26 offen
s_mov_b64 exec, s[34:35]
gated_mix__softmax_full_mha__ssm_conv_h3__prompt_kernel_nopf:
s_cmp_ge_u32 s7, 24
s_cbranch_scc1 gated_mix__softmax_full_mha__ssm_conv_h3__prompt_kernel_side
s_mul_i32 s5, s7, 43
s_lshr_b32 s5, s5, 8
s_mul_i32 s6, s5, 6
s_sub_u32 s6, s7, s6
s_and_b32 s32, s3, 1
s_mul_i32 s32, s32, 6
s_add_u32 s32, s32, s6
s_lshr_b32 s6, s3, 1
s_lshl_b32 s6, s6, 2
s_add_u32 s6, s6, s5
s_lshr_b32 s33, s32, 2
s_and_b32 s32, s32, 3
s_cmp_ge_u32 s4, 4
s_cbranch_scc1 gated_mix__softmax_full_mha__ssm_conv_h3__prompt_kernel_prod
s_mul_i32 s69, s32, 3
s_add_u32 s69, s69, s33
s_lshl_b32 s69, s69, 2
s_lshr_b32 s7, s4, 1
s_lshl_b32 s7, s7, 1
s_add_u32 s69, s69, s7
s_and_b32 s7, s4, 1
s_add_u32 s69, s69, s7
s_lshl_b32 s69, s69, 7
s_lshl_b32 s7, s6, 2
s_add_u32 s69, s69, s7
s_add_u32 s69, s69, 14684160
s_mov_b32 s71, 1
s_setprio 1
s_waitcnt lgkmcnt(0)
s_mov_b32 s65, 14680064
s_load_dword s64, s[60:61], s65
s_mov_b64 s[8:9], s[36:37]
s_mov_b32 s10, 0x1c0000
s_mov_b32 s11, 0x20000
s_mov_b64 s[12:13], s[38:39]
s_mov_b32 s14, 0x126000
s_mov_b32 s15, 0x20000
s_mov_b64 s[16:17], s[60:61]
s_mov_b32 s18, 0x10000000
s_mov_b32 s19, 0x20000
s_waitcnt lgkmcnt(0)
s_mul_i32 s64, s64, 0x9E3779B1
s_add_u32 s64, s64, 0x7F4A7C15
s_or_b32 s64, s64, 1
s_and_b32 s24, s4, 1
s_lshr_b32 s25, s4, 1
v_and_b32 v5, 31, v0
v_lshrrev_b32 v6, 5, v0
v_bfe_u32 v7, v0, 1, 3
v_xor_b32 v7, v6, v7
v_lshlrev_b32 v8, 7, v5
s_lshl_b32 s22, s24, 13
v_add_u32 v8, s22, v8
v_xor_b32 v9, 0, v7
v_lshl_add_u32 v40, v9, 4, v8
v_xor_b32 v9, 2, v7
v_lshl_add_u32 v41, v9, 4, v8
v_xor_b32 v9, 4, v7
v_lshl_add_u32 v42, v9, 4, v8
v_xor_b32 v9, 6, v7
v_lshl_add_u32 v43, v9, 4, v8
v_bfe_u32 v5, v0, 2, 2
v_lshlrev_b32 v5, 6, v5
v_lshl_add_u32 v5, v6, 11, v5
v_bfe_u32 v7, v0, 4, 1
v_lshl_add_u32 v5, v7, 5, v5
v_and_b32 v7, 3, v0
v_lshl_add_u32 v5, v7, 3, v5
s_lshl_b32 s22, s25, 9
s_add_u32 s22, s22, 16384
v_add_u32 v44, s22, v5
v_add_u32 v45, s22, v5
v_mov_b32 v128, 0
v_mov_b32 v129, 0
v_mov_b32 v130, 0
v_mov_b32 v131, 0
v_mov_b32 v132, 0
v_mov_b32 v133, 0
v_mov_b32 v134, 0
v_mov_b32 v135, 0
v_mov_b32 v136, 0
v_mov_b32 v137, 0
v_mov_b32 v138, 0
v_mov_b32 v139, 0
v_mov_b32 v140, 0
v_mov_b32 v141, 0
v_mov_b32 v142, 0
v_mov_b32 v143, 0
v_mov_b32 v144, 0
v_mov_b32 v145, 0
v_mov_b32 v146, 0
v_mov_b32 v147, 0
v_mov_b32 v148, 0
v_mov_b32 v149, 0
v_mov_b32 v150, 0
v_mov_b32 v151, 0
v_mov_b32 v152, 0
v_mov_b32 v153, 0
v_mov_b32 v154, 0
v_mov_b32 v155, 0
v_mov_b32 v156, 0
v_mov_b32 v157, 0
v_mov_b32 v158, 0
v_mov_b32 v159, 0
v_mov_b32 v160, 0
v_mov_b32 v161, 0
v_mov_b32 v162, 0
v_mov_b32 v163, 0
v_mov_b32 v164, 0
v_mov_b32 v165, 0
v_mov_b32 v166, 0
v_mov_b32 v167, 0
v_mov_b32 v168, 0
v_mov_b32 v169, 0
v_mov_b32 v170, 0
v_mov_b32 v171, 0
v_mov_b32 v172, 0
v_mov_b32 v173, 0
v_mov_b32 v174, 0
v_mov_b32 v175, 0
v_mov_b32 v176, 0
v_mov_b32 v177, 0
v_mov_b32 v178, 0
v_mov_b32 v179, 0
v_mov_b32 v180, 0
v_mov_b32 v181, 0
v_mov_b32 v182, 0
v_mov_b32 v183, 0
v_mov_b32 v184, 0
v_mov_b32 v185, 0
v_mov_b32 v186, 0
v_mov_b32 v187, 0
v_mov_b32 v188, 0
v_mov_b32 v189, 0
v_mov_b32 v190, 0
v_mov_b32 v191, 0
s_barrier
ds_read_b128 v[64:67], v40
ds_read_b128 v[68:71], v40 offset:4096
ds_read_b64_tr_b16 v[72:73], v44 offset:0
ds_read_b64_tr_b16 v[74:75], v44 offset:1024
ds_read_b64_tr_b16 v[76:77], v44 offset:256
ds_read_b64_tr_b16 v[78:79], v44 offset:1280
ds_read_b128 v[80:83], v41
ds_read_b128 v[84:87], v41 offset:4096
ds_read_b64_tr_b16 v[88:89], v44 offset:4096
ds_read_b64_tr_b16 v[90:91], v44 offset:5120
ds_read_b64_tr_b16 v[92:93], v44 offset:4352
ds_read_b64_tr_b16 v[94:95], v44 offset:5376
s_mov_b32 s27, 0xfffe0000
s_cmp_eq_u32 s33, 2
s_cbranch_scc1 gated_mix__softmax_full_mha__ssm_conv_h3__prompt_kernel_gv
s_mov_b32 s29, 0
gated_mix__softmax_full_mha__ssm_conv_h3__prompt_kernel_gloopt:
s_cmp_eq_u32 s29, 4
s_cselect_b32 s28, s27, 32768
s_waitcnt lgkmcnt(6)
v_mfma_f32_32x32x16_bf16 v[128:143], v[72:75], v[64:67], v[128:143]
ds_read_b128 v[96:99], v42
ds_read_b128 v[100:103], v42 offset:4096
v_mfma_f32_32x32x16_bf16 v[144:159], v[72:75], v[68:71], v[144:159]
ds_read_b64_tr_b16 v[104:105], v45 offset:8192
ds_read_b64_tr_b16 v[106:107], v45 offset:9216
v_mfma_f32_32x32x16_bf16 v[160:175], v[76:79], v[64:67], v[160:175]
ds_read_b64_tr_b16 v[108:109], v45 offset:8448
ds_read_b64_tr_b16 v[110:111], v45 offset:9472
v_mfma_f32_32x32x16_bf16 v[176:191], v[76:79], v[68:71], v[176:191]
s_waitcnt lgkmcnt(6)
v_mfma_f32_32x32x16_bf16 v[128:143], v[88:91], v[80:83], v[128:143]
ds_read_b128 v[112:115], v43
ds_read_b128 v[116:119], v43 offset:4096
v_mfma_f32_32x32x16_bf16 v[144:159], v[88:91], v[84:87], v[144:159]
ds_read_b64_tr_b16 v[120:121], v45 offset:12288
ds_read_b64_tr_b16 v[122:123], v45 offset:13312
v_mfma_f32_32x32x16_bf16 v[160:175], v[92:95], v[80:83], v[160:175]
ds_read_b64_tr_b16 v[124:125], v45 offset:12544
ds_read_b64_tr_b16 v[126:127], v45 offset:13568
v_mfma_f32_32x32x16_bf16 v[176:191], v[92:95], v[84:87], v[176:191]
s_cmp_eq_u32 s29, 6
s_cbranch_scc1 gated_mix__softmax_full_mha__ssm_conv_h3__prompt_kernel_gnbt
s_barrier
gated_mix__softmax_full_mha__ssm_conv_h3__prompt_kernel_gnbt:
v_add_u32 v40, s28, v40
v_add_u32 v41, s28, v41
v_add_u32 v44, s28, v44
s_waitcnt lgkmcnt(6)
v_mfma_f32_32x32x16_bf16 v[128:143], v[104:107], v[96:99], v[128:143]
ds_read_b128 v[64:67], v40
ds_read_b128 v[68:71], v40 offset:4096
v_mfma_f32_32x32x16_bf16 v[144:159], v[104:107], v[100:103], v[144:159]
ds_read_b64_tr_b16 v[72:73], v44 offset:0
ds_read_b64_tr_b16 v[74:75], v44 offset:1024
v_mfma_f32_32x32x16_bf16 v[160:175], v[108:111], v[96:99], v[160:175]
ds_read_b64_tr_b16 v[76:77], v44 offset:256
ds_read_b64_tr_b16 v[78:79], v44 offset:1280
v_mfma_f32_32x32x16_bf16 v[176:191], v[108:111], v[100:103], v[176:191]
s_waitcnt lgkmcnt(6)
v_mfma_f32_32x32x16_bf16 v[128:143], v[120:123], v[112:115], v[128:143]
ds_read_b128 v[80:83], v41
ds_read_b128 v[84:87], v41 offset:4096
v_mfma_f32_32x32x16_bf16 v[144:159], v[120:123], v[116:119], v[144:159]
ds_read_b64_tr_b16 v[88:89], v44 offset:4096
ds_read_b64_tr_b16 v[90:91], v44 offset:5120
v_mfma_f32_32x32x16_bf16 v[160:175], v[124:127], v[112:115], v[160:175]
ds_read_b64_tr_b16 v[92:93], v44 offset:4352
ds_read_b64_tr_b16 v[94:95], v44 offset:5376
v_mfma_f32_32x32x16_bf16 v[176:191], v[124:127], v[116:119], v[176:191]
v_add_u32 v42, s28, v42
v_add_u32 v43, s28, v43
v_add_u32 v45, s28, v45
s_add_u32 s29, s29, 1
s_cmp_lg_u32 s29, 7
s_cbranch_scc1 gated_mix__softmax_full_mha__ssm_conv_h3__prompt_kernel_gloopt
s_branch gated_mix__softmax_full_mha__ssm_conv_h3__prompt_kernel_gdone
gated_mix__softmax_full_mha__ssm_conv_h3__prompt_kernel_gv:
s_mov_b32 s29, 0
gated_mix__softmax_full_mha__ssm_conv_h3__prompt_kernel_gloopv:
s_cmp_eq_u32 s29, 4
s_cselect_b32 s28, s27, 32768
s_waitcnt lgkmcnt(6)
v_mfma_f32_32x32x16_bf16 v[128:143], v[64:67], v[72:75], v[128:143]
ds_read_b128 v[96:99], v42
ds_read_b128 v[100:103], v42 offset:4096
v_mfma_f32_32x32x16_bf16 v[144:159], v[68:71], v[72:75], v[144:159]
ds_read_b64_tr_b16 v[104:105], v45 offset:8192
ds_read_b64_tr_b16 v[106:107], v45 offset:9216
v_mfma_f32_32x32x16_bf16 v[160:175], v[64:67], v[76:79], v[160:175]
ds_read_b64_tr_b16 v[108:109], v45 offset:8448
ds_read_b64_tr_b16 v[110:111], v45 offset:9472
v_mfma_f32_32x32x16_bf16 v[176:191], v[68:71], v[76:79], v[176:191]
s_waitcnt lgkmcnt(6)
v_mfma_f32_32x32x16_bf16 v[128:143], v[80:83], v[88:91], v[128:143]
ds_read_b128 v[112:115], v43
ds_read_b128 v[116:119], v43 offset:4096
v_mfma_f32_32x32x16_bf16 v[144:159], v[84:87], v[88:91], v[144:159]
ds_read_b64_tr_b16 v[120:121], v45 offset:12288
ds_read_b64_tr_b16 v[122:123], v45 offset:13312
v_mfma_f32_32x32x16_bf16 v[160:175], v[80:83], v[92:95], v[160:175]
ds_read_b64_tr_b16 v[124:125], v45 offset:12544
ds_read_b64_tr_b16 v[126:127], v45 offset:13568
v_mfma_f32_32x32x16_bf16 v[176:191], v[84:87], v[92:95], v[176:191]
s_cmp_eq_u32 s29, 6
s_cbranch_scc1 gated_mix__softmax_full_mha__ssm_conv_h3__prompt_kernel_gnbv
s_barrier
gated_mix__softmax_full_mha__ssm_conv_h3__prompt_kernel_gnbv:
v_add_u32 v40, s28, v40
v_add_u32 v41, s28, v41
v_add_u32 v44, s28, v44
s_waitcnt lgkmcnt(6)
v_mfma_f32_32x32x16_bf16 v[128:143], v[96:99], v[104:107], v[128:143]
ds_read_b128 v[64:67], v40
ds_read_b128 v[68:71], v40 offset:4096
v_mfma_f32_32x32x16_bf16 v[144:159], v[100:103], v[104:107], v[144:159]
ds_read_b64_tr_b16 v[72:73], v44 offset:0
ds_read_b64_tr_b16 v[74:75], v44 offset:1024
v_mfma_f32_32x32x16_bf16 v[160:175], v[96:99], v[108:111], v[160:175]
ds_read_b64_tr_b16 v[76:77], v44 offset:256
ds_read_b64_tr_b16 v[78:79], v44 offset:1280
v_mfma_f32_32x32x16_bf16 v[176:191], v[100:103], v[108:111], v[176:191]
s_waitcnt lgkmcnt(6)
v_mfma_f32_32x32x16_bf16 v[128:143], v[112:115], v[120:123], v[128:143]
ds_read_b128 v[80:83], v41
ds_read_b128 v[84:87], v41 offset:4096
v_mfma_f32_32x32x16_bf16 v[144:159], v[116:119], v[120:123], v[144:159]
ds_read_b64_tr_b16 v[88:89], v44 offset:4096
ds_read_b64_tr_b16 v[90:91], v44 offset:5120
v_mfma_f32_32x32x16_bf16 v[160:175], v[112:115], v[124:127], v[160:175]
ds_read_b64_tr_b16 v[92:93], v44 offset:4352
ds_read_b64_tr_b16 v[94:95], v44 offset:5376
v_mfma_f32_32x32x16_bf16 v[176:191], v[116:119], v[124:127], v[176:191]
v_add_u32 v42, s28, v42
v_add_u32 v43, s28, v43
v_add_u32 v45, s28, v45
s_add_u32 s29, s29, 1
s_cmp_lg_u32 s29, 7
s_cbranch_scc1 gated_mix__softmax_full_mha__ssm_conv_h3__prompt_kernel_gloopv
gated_mix__softmax_full_mha__ssm_conv_h3__prompt_kernel_gdone:
s_waitcnt vmcnt(0) lgkmcnt(0)
s_lshl_b32 s30, s32, 2
s_lshl_b32 s31, s25, 1
s_add_u32 s30, s30, s31
s_lshl_b32 s30, s30, 6
s_lshl_b32 s31, s6, 2
s_add_u32 s30, s30, s31
s_lshl_b32 s31, s24, 1
s_add_u32 s30, s30, s31
v_lshlrev_b32 v1, 4, v0
s_cmp_eq_u32 s33, 2
s_cbranch_scc1 gated_mix__softmax_full_mha__ssm_conv_h3__prompt_kernel_epv
s_cmp_eq_u32 s33, 0
s_cselect_b32 s34, 0x3e8b97f6, 1.0
s_cselect_b32 s35, 0, 1.0
s_cselect_b32 s26, 11, 12
s_mov_b32 s27, 2097152
s_cselect_b32 s27, 0, s27
s_lshl_b32 s30, s30, s26
s_add_u32 s30, s30, s27
s_lshl_b32 s28, 64, s26
s_lshl_b32 s29, 1, s26
v_cmp_gt_u32 vcc, 32, v0
v_mov_b32 v5, s35
v_mov_b32 v6, s34
v_mov_b32 v7, s34
s_cmp_lg_u32 s33, 0
s_cbranch_scc1 isq_1
v_pk_mul_f32 v[128:129], v[128:129], v[6:7]
v_pk_mul_f32 v[130:131], v[130:131], v[6:7]
v_pk_mul_f32 v[132:133], v[132:133], v[6:7]
v_pk_mul_f32 v[134:135], v[134:135], v[6:7]
v_pk_mul_f32 v[136:137], v[136:137], v[6:7]
v_pk_mul_f32 v[138:139], v[138:139], v[6:7]
v_pk_mul_f32 v[140:141], v[140:141], v[6:7]
v_pk_mul_f32 v[142:143], v[142:143], v[6:7]
v_pk_mul_f32 v[144:145], v[144:145], v[6:7]
v_pk_mul_f32 v[146:147], v[146:147], v[6:7]
v_pk_mul_f32 v[148:149], v[148:149], v[6:7]
v_pk_mul_f32 v[150:151], v[150:151], v[6:7]
v_pk_mul_f32 v[152:153], v[152:153], v[6:7]
v_pk_mul_f32 v[154:155], v[154:155], v[6:7]
v_pk_mul_f32 v[156:157], v[156:157], v[6:7]
v_pk_mul_f32 v[158:159], v[158:159], v[6:7]
v_pk_mul_f32 v[160:161], v[160:161], v[6:7]
v_pk_mul_f32 v[162:163], v[162:163], v[6:7]
v_pk_mul_f32 v[164:165], v[164:165], v[6:7]
v_pk_mul_f32 v[166:167], v[166:167], v[6:7]
v_pk_mul_f32 v[168:169], v[168:169], v[6:7]
v_pk_mul_f32 v[170:171], v[170:171], v[6:7]
v_pk_mul_f32 v[172:173], v[172:173], v[6:7]
v_pk_mul_f32 v[174:175], v[174:175], v[6:7]
v_pk_mul_f32 v[176:177], v[176:177], v[6:7]
v_pk_mul_f32 v[178:179], v[178:179], v[6:7]
v_pk_mul_f32 v[180:181], v[180:181], v[6:7]
v_pk_mul_f32 v[182:183], v[182:183], v[6:7]
v_pk_mul_f32 v[184:185], v[184:185], v[6:7]
v_pk_mul_f32 v[186:187], v[186:187], v[6:7]
v_pk_mul_f32 v[188:189], v[188:189], v[6:7]
v_pk_mul_f32 v[190:191], v[190:191], v[6:7]
isq_1:
v_cndmask_b32 v140, v5, v140, vcc
v_cndmask_b32 v141, v5, v141, vcc
v_cndmask_b32 v142, v5, v142, vcc
v_cndmask_b32 v143, 0, v143, vcc
v_cvt_pk_bf16_f32 v16, v128, v129
v_cvt_pk_bf16_f32 v17, v130, v131
v_cvt_pk_bf16_f32 v18, v132, v133
v_cvt_pk_bf16_f32 v19, v134, v135
v_cvt_pk_bf16_f32 v20, v136, v137
v_cvt_pk_bf16_f32 v21, v138, v139
v_cvt_pk_bf16_f32 v22, v140, v141
v_cvt_pk_bf16_f32 v23, v142, v143
buffer_store_dwordx4 v[16:19], v1, s[16:19], s30 offen sc1
buffer_store_dwordx4 v[20:23], v1, s[16:19], s30 offen offset:1024 sc1
v_cndmask_b32 v156, v5, v156, vcc
v_cndmask_b32 v157, v5, v157, vcc
v_cndmask_b32 v158, v5, v158, vcc
v_cndmask_b32 v159, 0, v159, vcc
v_cvt_pk_bf16_f32 v24, v144, v145
v_cvt_pk_bf16_f32 v25, v146, v147
v_cvt_pk_bf16_f32 v26, v148, v149
v_cvt_pk_bf16_f32 v27, v150, v151
v_cvt_pk_bf16_f32 v28, v152, v153
v_cvt_pk_bf16_f32 v29, v154, v155
v_cvt_pk_bf16_f32 v30, v156, v157
v_cvt_pk_bf16_f32 v31, v158, v159
s_add_u32 s31, s30, s29
buffer_store_dwordx4 v[24:27], v1, s[16:19], s31 offen sc1
buffer_store_dwordx4 v[28:31], v1, s[16:19], s31 offen offset:1024 sc1
v_cndmask_b32 v172, v5, v172, vcc
v_cndmask_b32 v173, v5, v173, vcc
v_cndmask_b32 v174, v5, v174, vcc
v_cndmask_b32 v175, 0, v175, vcc
v_cvt_pk_bf16_f32 v32, v160, v161
v_cvt_pk_bf16_f32 v33, v162, v163
v_cvt_pk_bf16_f32 v34, v164, v165
v_cvt_pk_bf16_f32 v35, v166, v167
v_cvt_pk_bf16_f32 v36, v168, v169
v_cvt_pk_bf16_f32 v37, v170, v171
v_cvt_pk_bf16_f32 v38, v172, v173
v_cvt_pk_bf16_f32 v39, v174, v175
s_add_u32 s31, s30, s28
buffer_store_dwordx4 v[32:35], v1, s[16:19], s31 offen sc1
buffer_store_dwordx4 v[36:39], v1, s[16:19], s31 offen offset:1024 sc1
v_cndmask_b32 v188, v5, v188, vcc
v_cndmask_b32 v189, v5, v189, vcc
v_cndmask_b32 v190, v5, v190, vcc
v_cndmask_b32 v191, 0, v191, vcc
v_cvt_pk_bf16_f32 v40, v176, v177
v_cvt_pk_bf16_f32 v41, v178, v179
v_cvt_pk_bf16_f32 v42, v180, v181
v_cvt_pk_bf16_f32 v43, v182, v183
v_cvt_pk_bf16_f32 v44, v184, v185
v_cvt_pk_bf16_f32 v45, v186, v187
v_cvt_pk_bf16_f32 v46, v188, v189
v_cvt_pk_bf16_f32 v47, v190, v191
s_add_u32 s31, s31, s29
buffer_store_dwordx4 v[40:43], v1, s[16:19], s31 offen sc1
buffer_store_dwordx4 v[44:47], v1, s[16:19], s31 offen offset:1024 sc1
s_branch gated_mix__softmax_full_mha__ssm_conv_h3__prompt_kernel_epd
gated_mix__softmax_full_mha__ssm_conv_h3__prompt_kernel_epv:
s_lshl_b32 s30, s30, 12
s_add_u32 s30, s30, 2099200
v_and_b32 v5, 31, v0
v_cmp_eq_u32 s[34:35], 28, v5
v_mov_b32 v6, 0
v_mov_b32 v7, 0x3f803f80
v_cmp_gt_u32 vcc, 28, v5
v_cndmask_b32 v6, v6, v7, s[34:35]
v_cvt_pk_bf16_f32 v16, v128, v129
v_cvt_pk_bf16_f32 v17, v130, v131
v_cvt_pk_bf16_f32 v18, v132, v133
v_cvt_pk_bf16_f32 v19, v134, v135
v_cvt_pk_bf16_f32 v20, v136, v137
v_cvt_pk_bf16_f32 v21, v138, v139
v_cvt_pk_bf16_f32 v22, v140, v141
v_cvt_pk_bf16_f32 v23, v142, v143
v_cndmask_b32 v16, v6, v16, vcc
v_cndmask_b32 v17, v6, v17, vcc
v_cndmask_b32 v18, v6, v18, vcc
v_cndmask_b32 v19, v6, v19, vcc
v_cndmask_b32 v20, v6, v20, vcc
v_cndmask_b32 v21, v6, v21, vcc
v_cndmask_b32 v22, v6, v22, vcc
v_cndmask_b32 v23, v6, v23, vcc
s_add_u32 s31, s30, 0
buffer_store_dwordx4 v[16:19], v1, s[16:19], s31 offen sc1
buffer_store_dwordx4 v[20:23], v1, s[16:19], s31 offen offset:1024 sc1
v_cvt_pk_bf16_f32 v24, v144, v145
v_cvt_pk_bf16_f32 v25, v146, v147
v_cvt_pk_bf16_f32 v26, v148, v149
v_cvt_pk_bf16_f32 v27, v150, v151
v_cvt_pk_bf16_f32 v28, v152, v153
v_cvt_pk_bf16_f32 v29, v154, v155
v_cvt_pk_bf16_f32 v30, v156, v157
v_cvt_pk_bf16_f32 v31, v158, v159
v_cndmask_b32 v24, v6, v24, vcc
v_cndmask_b32 v25, v6, v25, vcc
v_cndmask_b32 v26, v6, v26, vcc
v_cndmask_b32 v27, v6, v27, vcc
v_cndmask_b32 v28, v6, v28, vcc
v_cndmask_b32 v29, v6, v29, vcc
v_cndmask_b32 v30, v6, v30, vcc
v_cndmask_b32 v31, v6, v31, vcc
s_add_u32 s31, s30, 4096
buffer_store_dwordx4 v[24:27], v1, s[16:19], s31 offen sc1
buffer_store_dwordx4 v[28:31], v1, s[16:19], s31 offen offset:1024 sc1
v_cvt_pk_bf16_f32 v32, v160, v161
v_cvt_pk_bf16_f32 v33, v162, v163
v_cvt_pk_bf16_f32 v34, v164, v165
v_cvt_pk_bf16_f32 v35, v166, v167
v_cvt_pk_bf16_f32 v36, v168, v169
v_cvt_pk_bf16_f32 v37, v170, v171
v_cvt_pk_bf16_f32 v38, v172, v173
v_cvt_pk_bf16_f32 v39, v174, v175
v_cndmask_b32 v32, v6, v32, vcc
v_cndmask_b32 v33, v6, v33, vcc
v_cndmask_b32 v34, v6, v34, vcc
v_cndmask_b32 v35, v6, v35, vcc
v_cndmask_b32 v36, v6, v36, vcc
v_cndmask_b32 v37, v6, v37, vcc
v_cndmask_b32 v38, v6, v38, vcc
v_cndmask_b32 v39, v6, v39, vcc
s_add_u32 s31, s30, 262144
buffer_store_dwordx4 v[32:35], v1, s[16:19], s31 offen sc1
buffer_store_dwordx4 v[36:39], v1, s[16:19], s31 offen offset:1024 sc1
v_cvt_pk_bf16_f32 v40, v176, v177
v_cvt_pk_bf16_f32 v41, v178, v179
v_cvt_pk_bf16_f32 v42, v180, v181
v_cvt_pk_bf16_f32 v43, v182, v183
v_cvt_pk_bf16_f32 v44, v184, v185
v_cvt_pk_bf16_f32 v45, v186, v187
v_cvt_pk_bf16_f32 v46, v188, v189
v_cvt_pk_bf16_f32 v47, v190, v191
v_cndmask_b32 v40, v6, v40, vcc
v_cndmask_b32 v41, v6, v41, vcc
v_cndmask_b32 v42, v6, v42, vcc
v_cndmask_b32 v43, v6, v43, vcc
v_cndmask_b32 v44, v6, v44, vcc
v_cndmask_b32 v45, v6, v45, vcc
v_cndmask_b32 v46, v6, v46, vcc
v_cndmask_b32 v47, v6, v47, vcc
s_add_u32 s31, s30, 266240
buffer_store_dwordx4 v[40:43], v1, s[16:19], s31 offen sc1
buffer_store_dwordx4 v[44:47], v1, s[16:19], s31 offen offset:1024 sc1
gated_mix__softmax_full_mha__ssm_conv_h3__prompt_kernel_epd:
s_setprio 0
s_waitcnt vmcnt(0)
v_mov_b32 v250, s64
v_lshlrev_b32 v251, 7, v0
s_mov_b64 s[66:67], exec
s_mov_b64 exec, 1
buffer_store_dword v250, v251, s[16:19], s69 offen sc1
s_mov_b64 exec, s[66:67]
s_branch gated_mix__softmax_full_mha__ssm_conv_h3__prompt_kernel_cwait1
gated_mix__softmax_full_mha__ssm_conv_h3__prompt_kernel_prod:
s_sub_u32 s62, s4, 4
s_mul_i32 s63, s33, 896
s_mul_i32 s7, s32, 224
s_add_u32 s63, s63, s7
v_lshlrev_b32 v1, 4, v0
v_lshrrev_b32 v5, 3, v0
v_mul_u32_u24 v5, 896, v5
v_and_b32 v6, 7, v0
v_lshrrev_b32 v7, 4, v0
v_xor_b32 v8, v6, v7
v_lshl_add_u32 v2, v8, 4, v5
v_xor_b32 v8, 4, v8
v_lshl_add_u32 v3, v8, 4, v5
v_bfe_u32 v5, v0, 2, 2
v_mul_u32_u24 v5, 2688, v5
v_mul_u32_u24 v6, 56, v7
v_add_u32 v5, v5, v6
v_and_b32 v6, 3, v0
v_lshl_add_u32 v4, v6, 4, v5
s_lshl_b32 s20, s6, 7
s_lshl_b32 s7, s62, 5
s_add_u32 s20, s20, s7
s_mul_i32 s20, s20, 896
s_mul_i32 s21, s62, 43008
s_add_u32 s21, s21, s63
s_lshl_b32 s22, s62, 12
s_waitcnt lgkmcnt(0)
s_mov_b32 s65, 14680064
s_load_dword s64, s[60:61], s65
s_mov_b64 s[8:9], s[36:37]
s_mov_b32 s10, 0x1c0000
s_mov_b32 s11, 0x20000
s_mov_b64 s[12:13], s[38:39]
s_mov_b32 s14, 0x126000
s_mov_b32 s15, 0x20000
s_mov_b64 s[16:17], s[60:61]
s_mov_b32 s18, 0x10000000
s_mov_b32 s19, 0x20000
s_add_u32 m0, s22, 0
s_add_u32 s30, s20, 0
buffer_load_dwordx4 v2, s[8:11], s30 offen lds
s_add_u32 m0, s22, 1024
s_add_u32 s30, s20, 7168
buffer_load_dwordx4 v3, s[8:11], s30 offen lds
s_add_u32 m0, s22, 2048
s_add_u32 s30, s20, 14336
buffer_load_dwordx4 v2, s[8:11], s30 offen lds
s_add_u32 m0, s22, 3072
s_add_u32 s30, s20, 21504
buffer_load_dwordx4 v3, s[8:11], s30 offen lds
s_add_u32 m0, s22, 16384
s_add_u32 s31, s21, 0
buffer_load_dwordx4 v4, s[12:15], s31 offen lds
s_add_u32 m0, s22, 17408
s_add_u32 s31, s21, 10752
buffer_load_dwordx4 v4, s[12:15], s31 offen lds
s_add_u32 m0, s22, 18432
s_add_u32 s31, s21, 21504
buffer_load_dwordx4 v4, s[12:15], s31 offen lds
s_add_u32 m0, s22, 19456
s_add_u32 s31, s21, 32256
buffer_load_dwordx4 v4, s[12:15], s31 offen lds
s_add_u32 m0, s22, 32768
s_add_u32 s30, s20, 128
buffer_load_dwordx4 v2, s[8:11], s30 offen lds
s_add_u32 m0, s22, 33792
s_add_u32 s30, s20, 7296
buffer_load_dwordx4 v3, s[8:11], s30 offen lds
s_add_u32 m0, s22, 34816
s_add_u32 s30, s20, 14464
buffer_load_dwordx4 v2, s[8:11], s30 offen lds
s_add_u32 m0, s22, 35840
s_add_u32 s30, s20, 21632
buffer_load_dwordx4 v3, s[8:11], s30 offen lds
s_add_u32 m0, s22, 49152
s_add_u32 s31, s21, 172032
buffer_load_dwordx4 v4, s[12:15], s31 offen lds
s_add_u32 m0, s22, 50176
s_add_u32 s31, s21, 182784
buffer_load_dwordx4 v4, s[12:15], s31 offen lds
s_add_u32 m0, s22, 51200
s_add_u32 s31, s21, 193536
buffer_load_dwordx4 v4, s[12:15], s31 offen lds
s_add_u32 m0, s22, 52224
s_add_u32 s31, s21, 204288
buffer_load_dwordx4 v4, s[12:15], s31 offen lds
s_waitcnt vmcnt(8)
s_barrier
s_add_u32 m0, s22, 65536
s_add_u32 s30, s20, 256
buffer_load_dwordx4 v2, s[8:11], s30 offen lds
s_add_u32 m0, s22, 66560
s_add_u32 s30, s20, 7424
buffer_load_dwordx4 v3, s[8:11], s30 offen lds
s_add_u32 m0, s22, 67584
s_add_u32 s30, s20, 14592
buffer_load_dwordx4 v2, s[8:11], s30 offen lds
s_add_u32 m0, s22, 68608
s_add_u32 s30, s20, 21760
buffer_load_dwordx4 v3, s[8:11], s30 offen lds
s_add_u32 m0, s22, 81920
s_add_u32 s31, s21, 344064
buffer_load_dwordx4 v4, s[12:15], s31 offen lds
s_add_u32 m0, s22, 82944
s_add_u32 s31, s21, 354816
buffer_load_dwordx4 v4, s[12:15], s31 offen lds
s_add_u32 m0, s22, 83968
s_add_u32 s31, s21, 365568
buffer_load_dwordx4 v4, s[12:15], s31 offen lds
s_add_u32 m0, s22, 84992
s_add_u32 s31, s21, 376320
buffer_load_dwordx4 v4, s[12:15], s31 offen lds
s_waitcnt vmcnt(8)
s_barrier
s_add_u32 m0, s22, 98304
s_add_u32 s30, s20, 384
buffer_load_dwordx4 v2, s[8:11], s30 offen lds
s_add_u32 m0, s22, 99328
s_add_u32 s30, s20, 7552
buffer_load_dwordx4 v3, s[8:11], s30 offen lds
s_add_u32 m0, s22, 100352
s_add_u32 s30, s20, 14720
buffer_load_dwordx4 v2, s[8:11], s30 offen lds
s_add_u32 m0, s22, 101376
s_add_u32 s30, s20, 21888
buffer_load_dwordx4 v3, s[8:11], s30 offen lds
s_add_u32 m0, s22, 114688
s_add_u32 s31, s21, 516096
buffer_load_dwordx4 v4, s[12:15], s31 offen lds
s_add_u32 m0, s22, 115712
s_add_u32 s31, s21, 526848
buffer_load_dwordx4 v4, s[12:15], s31 offen lds
s_add_u32 m0, s22, 116736
s_add_u32 s31, s21, 537600
buffer_load_dwordx4 v4, s[12:15], s31 offen lds
s_add_u32 m0, s22, 117760
s_add_u32 s31, s21, 548352
buffer_load_dwordx4 v4, s[12:15], s31 offen lds
s_waitcnt vmcnt(8)
s_barrier
s_add_u32 m0, s22, 131072
s_add_u32 s30, s20, 512
buffer_load_dwordx4 v2, s[8:11], s30 offen lds
s_add_u32 m0, s22, 132096
s_add_u32 s30, s20, 7680
buffer_load_dwordx4 v3, s[8:11], s30 offen lds
s_add_u32 m0, s22, 133120
s_add_u32 s30, s20, 14848
buffer_load_dwordx4 v2, s[8:11], s30 offen lds
s_add_u32 m0, s22, 134144
s_add_u32 s30, s20, 22016
buffer_load_dwordx4 v3, s[8:11], s30 offen lds
s_add_u32 m0, s22, 147456
s_add_u32 s31, s21, 688128
buffer_load_dwordx4 v4, s[12:15], s31 offen lds
s_add_u32 m0, s22, 148480
s_add_u32 s31, s21, 698880
buffer_load_dwordx4 v4, s[12:15], s31 offen lds
s_add_u32 m0, s22, 149504
s_add_u32 s31, s21, 709632
buffer_load_dwordx4 v4, s[12:15], s31 offen lds
s_add_u32 m0, s22, 150528
s_add_u32 s31, s21, 720384
buffer_load_dwordx4 v4, s[12:15], s31 offen lds
s_waitcnt vmcnt(8)
s_barrier
s_add_u32 m0, s22, 0
s_add_u32 s30, s20, 640
buffer_load_dwordx4 v2, s[8:11], s30 offen lds
s_add_u32 m0, s22, 1024
s_add_u32 s30, s20, 7808
buffer_load_dwordx4 v3, s[8:11], s30 offen lds
s_add_u32 m0, s22, 2048
s_add_u32 s30, s20, 14976
buffer_load_dwordx4 v2, s[8:11], s30 offen lds
s_add_u32 m0, s22, 3072
s_add_u32 s30, s20, 22144
buffer_load_dwordx4 v3, s[8:11], s30 offen lds
s_add_u32 m0, s22, 16384
s_add_u32 s31, s21, 860160
buffer_load_dwordx4 v4, s[12:15], s31 offen lds
s_add_u32 m0, s22, 17408
s_add_u32 s31, s21, 870912
buffer_load_dwordx4 v4, s[12:15], s31 offen lds
s_add_u32 m0, s22, 18432
s_add_u32 s31, s21, 881664
buffer_load_dwordx4 v4, s[12:15], s31 offen lds
s_add_u32 m0, s22, 19456
s_add_u32 s31, s21, 892416
buffer_load_dwordx4 v4, s[12:15], s31 offen lds
s_waitcnt vmcnt(8)
s_barrier
s_add_u32 m0, s22, 32768
s_add_u32 s30, s20, 768
buffer_load_dwordx4 v2, s[8:11], s30 offen lds
s_add_u32 m0, s22, 33792
s_add_u32 s30, s20, 7936
buffer_load_dwordx4 v3, s[8:11], s30 offen lds
s_add_u32 m0, s22, 34816
s_add_u32 s30, s20, 15104
buffer_load_dwordx4 v2, s[8:11], s30 offen lds
s_add_u32 m0, s22, 35840
s_add_u32 s30, s20, 22272
buffer_load_dwordx4 v3, s[8:11], s30 offen lds
s_add_u32 m0, s22, 49152
s_add_u32 s31, s21, 1032192
buffer_load_dwordx4 v4, s[12:15], s31 offen lds
s_add_u32 m0, s22, 50176
s_add_u32 s31, s21, 1042944
buffer_load_dwordx4 v4, s[12:15], s31 offen lds
s_add_u32 m0, s22, 51200
s_add_u32 s31, s21, 1053696
buffer_load_dwordx4 v4, s[12:15], s31 offen lds
s_add_u32 m0, s22, 52224
s_add_u32 s31, s21, 1064448
buffer_load_dwordx4 v4, s[12:15], s31 offen lds
s_waitcnt vmcnt(8)
s_barrier
s_waitcnt vmcnt(0)
s_barrier
s_waitcnt lgkmcnt(0)
s_mul_i32 s64, s64, 0x9E3779B1
s_add_u32 s64, s64, 0x7F4A7C15
s_or_b32 s64, s64, 1
s_cmp_lg_u32 s4, 4
s_cbranch_scc1 gated_mix__softmax_full_mha__ssm_conv_h3__prompt_kernel_prep0
s_mov_b64 s[20:21], s[58:59]
s_mov_b32 s22, 0x100
s_mov_b32 s23, 0x20000
v_mov_b32 v250, 1
v_mov_b32 v251, 0
s_mov_b64 s[66:67], exec
s_mov_b64 exec, 1
buffer_atomic_add v250, v251, s[20:23], 0 offen sc1
s_mov_b64 exec, s[66:67]
s_branch gated_mix__softmax_full_mha__ssm_conv_h3__prompt_kernel_prep0
gated_mix__softmax_full_mha__ssm_conv_h3__prompt_kernel_side:
s_sub_u32 s7, s7, 24
s_and_b32 s5, s7, 1
s_lshr_b32 s7, s7, 1
s_lshl_b32 s6, s3, 2
s_add_u32 s6, s6, s7
s_lshl_b32 s69, s5, 10
s_lshl_b32 s7, s6, 2
s_add_u32 s69, s69, s7
s_add_u32 s69, s69, 14692352
v_min_u32 v2, 55, v0
v_cmp_le_u32 vcc, 28, v2
s_lshl_b32 s33, s6, 6
s_lshl_b32 s62, s4, 3
s_add_u32 s33, s33, s62
v_cndmask_b32 v3, 0, 1, vcc
v_cndmask_b32 v4, 0, 28, vcc
v_sub_u32 v2, v2, v4
v_lshlrev_b32 v4, 2, v3
v_add_u32 v4, s33, v4
v_subrev_u32 v4, 3, v4
v_mul_i32_i24 v4, 896, v4
s_mul_i32 s62, s5, 448
v_lshlrev_b32 v5, 4, v2
v_add_u32 v5, s62, v5
v_add_u32 v6, v4, v5
v_lshlrev_b32 v8, 2, v5
s_waitcnt lgkmcnt(0)
s_mov_b32 s65, 14680064
s_load_dword s64, s[60:61], s65
s_mov_b64 s[8:9], s[36:37]
s_mov_b32 s10, 0x1c0000
s_mov_b32 s11, 0x20000
s_mov_b64 s[12:13], s[38:39]
s_mov_b32 s14, 0x126000
s_mov_b32 s15, 0x20000
s_mov_b64 s[16:17], s[60:61]
s_mov_b32 s18, 0x10000000
s_mov_b32 s19, 0x20000
s_mov_b64 s[20:21], s[44:45]
s_mov_b32 s22, 0x1c0000
s_mov_b32 s23, 0x20000
s_mov_b64 s[24:25], s[46:47]
s_mov_b32 s26, 0x1c0000
s_mov_b32 s27, 0x20000
s_mov_b64 s[28:29], s[48:49]
s_mov_b32 s30, 0xe00
s_mov_b32 s31, 0x20000
buffer_load_dwordx4 v[16:19], v6, s[20:23], 0 offen
v_add_u32 v9, 896, v6
buffer_load_dwordx4 v[20:23], v9, s[20:23], 0 offen
v_add_u32 v9, 1792, v6
buffer_load_dwordx4 v[24:27], v9, s[20:23], 0 offen
v_add_u32 v10, 2688, v6
buffer_load_dwordx4 v[28:31], v10, s[20:23], 0 offen offset:0
buffer_load_dwordx4 v[32:35], v10, s[20:23], 0 offen offset:896
buffer_load_dwordx4 v[36:39], v10, s[20:23], 0 offen offset:1792
buffer_load_dwordx4 v[40:43], v10, s[20:23], 0 offen offset:2688
buffer_load_dwordx4 v[44:47], v10, s[24:27], 0 offen offset:0
buffer_load_dwordx4 v[48:51], v10, s[24:27], 0 offen offset:896
buffer_load_dwordx4 v[52:55], v10, s[24:27], 0 offen offset:1792
buffer_load_dwordx4 v[56:59], v10, s[24:27], 0 offen offset:2688
buffer_load_dwordx4 v[60:63], v8, s[28:31], 0 offen offset:0
buffer_load_dwordx4 v[64:67], v8, s[28:31], 0 offen offset:16
buffer_load_dwordx4 v[68:71], v8, s[28:31], 0 offen offset:32
buffer_load_dwordx4 v[72:75], v8, s[28:31], 0 offen offset:48
v_lshlrev_b32 v1, 4, v0
s_cmp_lt_u32 s4, 4
s_cbranch_scc1 sh_2
s_sub_u32 s26, s4, 4
s_lshl_b32 s27, s2, 13
s_lshl_b32 s34, s26, 10
v_add_u32 v12, s34, v1
v_subrev_u32 v13, 32, v1
v_subrev_u32 v14, 16, v1
s_add_u32 s28, s50, s27
s_addc_u32 s29, s51, 0
s_mov_b64 s[92:93], s[28:29]
s_mov_b32 s94, 4096
s_mov_b32 s95, 0x20000
buffer_load_dwordx4 v[192:195], v12, s[92:95], 0 offen
buffer_load_dwordx2 v[196:197], v12, s[92:95], 0 offen offset:16
buffer_load_dwordx4 v[200:203], v13, s[92:95], 0 offen
buffer_load_dwordx2 v[204:205], v14, s[92:95], 0 offen
s_add_u32 s28, s50, s27
s_addc_u32 s29, s51, 0
s_add_u32 s28, s28, 4096
s_addc_u32 s29, s29, 0
s_mov_b64 s[92:93], s[28:29]
s_mov_b32 s94, 4096
s_mov_b32 s95, 0x20000
buffer_load_dwordx4 v[208:211], v12, s[92:95], 0 offen
buffer_load_dwordx2 v[212:213], v12, s[92:95], 0 offen offset:16
buffer_load_dwordx4 v[216:219], v13, s[92:95], 0 offen
buffer_load_dwordx2 v[220:221], v14, s[92:95], 0 offen
sh_2:
s_sub_u32 s62, 7, s4
v_and_b32 v9, 7, v2
v_xor_b32 v9, s62, v9
v_lshlrev_b32 v9, 4, v9
v_lshlrev_b32 v11, 10, v2
v_add_u32 v9, v9, v11
v_xor_b32 v11, 1, v3
v_lshl_add_u32 v9, v11, 3, v9
s_cmp_ge_u32 s4, 4
s_cbranch_scc1 wl_3
s_waitcnt vmcnt(0)
s_branch wj_4
wl_3:
s_waitcnt vmcnt(8)
wj_4:
v_lshlrev_b32 v76, 16, v60
v_and_b32 v77, 0xffff0000, v60
v_lshlrev_b32 v78, 16, v61
v_and_b32 v79, 0xffff0000, v61
v_lshlrev_b32 v80, 16, v16
v_lshlrev_b32 v81, 16, v20
v_lshlrev_b32 v82, 16, v24
v_lshlrev_b32 v83, 16, v28
v_lshlrev_b32 v84, 16, v32
v_lshlrev_b32 v85, 16, v36
v_lshlrev_b32 v86, 16, v40
v_mul_f32 v88, v79, v80
v_mul_f32 v89, v79, v81
v_mul_f32 v90, v79, v82
v_mul_f32 v91, v79, v83
v_fmac_f32 v88, v78, v81
v_fmac_f32 v89, v78, v82
v_fmac_f32 v90, v78, v83
v_fmac_f32 v91, v78, v84
v_fmac_f32 v88, v77, v82
v_fmac_f32 v89, v77, v83
v_fmac_f32 v90, v77, v84
v_fmac_f32 v91, v77, v85
v_fmac_f32 v88, v76, v83
v_fmac_f32 v89, v76, v84
v_fmac_f32 v90, v76, v85
v_fmac_f32 v91, v76, v86
v_lshlrev_b32 v80, 16, v44
v_lshlrev_b32 v81, 16, v48
v_lshlrev_b32 v82, 16, v52
v_lshlrev_b32 v83, 16, v56
v_mul_f32 v88, v88, v80
v_mul_f32 v89, v89, v81
v_mul_f32 v90, v90, v82
v_mul_f32 v91, v91, v83
v_cvt_pk_bf16_f32 v96, v91, v90
v_cvt_pk_bf16_f32 v97, v89, v88
v_lshlrev_b32 v76, 16, v62
v_and_b32 v77, 0xffff0000, v62
v_lshlrev_b32 v78, 16, v63
v_and_b32 v79, 0xffff0000, v63
v_and_b32 v80, 0xffff0000, v16
v_and_b32 v81, 0xffff0000, v20
v_and_b32 v82, 0xffff0000, v24
v_and_b32 v83, 0xffff0000, v28
v_and_b32 v84, 0xffff0000, v32
v_and_b32 v85, 0xffff0000, v36
v_and_b32 v86, 0xffff0000, v40
v_mul_f32 v88, v79, v80
v_mul_f32 v89, v79, v81
v_mul_f32 v90, v79, v82
v_mul_f32 v91, v79, v83
v_fmac_f32 v88, v78, v81
v_fmac_f32 v89, v78, v82
v_fmac_f32 v90, v78, v83
v_fmac_f32 v91, v78, v84
v_fmac_f32 v88, v77, v82
v_fmac_f32 v89, v77, v83
v_fmac_f32 v90, v77, v84
v_fmac_f32 v91, v77, v85
v_fmac_f32 v88, v76, v83
v_fmac_f32 v89, v76, v84
v_fmac_f32 v90, v76, v85
v_fmac_f32 v91, v76, v86
v_and_b32 v80, 0xffff0000, v44
v_and_b32 v81, 0xffff0000, v48
v_and_b32 v82, 0xffff0000, v52
v_and_b32 v83, 0xffff0000, v56
v_mul_f32 v88, v88, v80
v_mul_f32 v89, v89, v81
v_mul_f32 v90, v90, v82
v_mul_f32 v91, v91, v83
v_cvt_pk_bf16_f32 v98, v91, v90
v_cvt_pk_bf16_f32 v99, v89, v88
v_lshlrev_b32 v76, 16, v64
v_and_b32 v77, 0xffff0000, v64
v_lshlrev_b32 v78, 16, v65
v_and_b32 v79, 0xffff0000, v65
v_lshlrev_b32 v80, 16, v17
v_lshlrev_b32 v81, 16, v21
v_lshlrev_b32 v82, 16, v25
v_lshlrev_b32 v83, 16, v29
v_lshlrev_b32 v84, 16, v33
v_lshlrev_b32 v85, 16, v37
v_lshlrev_b32 v86, 16, v41
v_mul_f32 v88, v79, v80
v_mul_f32 v89, v79, v81
v_mul_f32 v90, v79, v82
v_mul_f32 v91, v79, v83
v_fmac_f32 v88, v78, v81
v_fmac_f32 v89, v78, v82
v_fmac_f32 v90, v78, v83
v_fmac_f32 v91, v78, v84
v_fmac_f32 v88, v77, v82
v_fmac_f32 v89, v77, v83
v_fmac_f32 v90, v77, v84
v_fmac_f32 v91, v77, v85
v_fmac_f32 v88, v76, v83
v_fmac_f32 v89, v76, v84
v_fmac_f32 v90, v76, v85
v_fmac_f32 v91, v76, v86
v_lshlrev_b32 v80, 16, v45
v_lshlrev_b32 v81, 16, v49
v_lshlrev_b32 v82, 16, v53
v_lshlrev_b32 v83, 16, v57
v_mul_f32 v88, v88, v80
v_mul_f32 v89, v89, v81
v_mul_f32 v90, v90, v82
v_mul_f32 v91, v91, v83
v_cvt_pk_bf16_f32 v100, v91, v90
v_cvt_pk_bf16_f32 v101, v89, v88
v_lshlrev_b32 v76, 16, v66
v_and_b32 v77, 0xffff0000, v66
v_lshlrev_b32 v78, 16, v67
v_and_b32 v79, 0xffff0000, v67
v_and_b32 v80, 0xffff0000, v17
v_and_b32 v81, 0xffff0000, v21
v_and_b32 v82, 0xffff0000, v25
v_and_b32 v83, 0xffff0000, v29
v_and_b32 v84, 0xffff0000, v33
v_and_b32 v85, 0xffff0000, v37
v_and_b32 v86, 0xffff0000, v41
v_mul_f32 v88, v79, v80
v_mul_f32 v89, v79, v81
v_mul_f32 v90, v79, v82
v_mul_f32 v91, v79, v83
v_fmac_f32 v88, v78, v81
v_fmac_f32 v89, v78, v82
v_fmac_f32 v90, v78, v83
v_fmac_f32 v91, v78, v84
v_fmac_f32 v88, v77, v82
v_fmac_f32 v89, v77, v83
v_fmac_f32 v90, v77, v84
v_fmac_f32 v91, v77, v85
v_fmac_f32 v88, v76, v83
v_fmac_f32 v89, v76, v84
v_fmac_f32 v90, v76, v85
v_fmac_f32 v91, v76, v86
v_and_b32 v80, 0xffff0000, v45
v_and_b32 v81, 0xffff0000, v49
v_and_b32 v82, 0xffff0000, v53
v_and_b32 v83, 0xffff0000, v57
v_mul_f32 v88, v88, v80
v_mul_f32 v89, v89, v81
v_mul_f32 v90, v90, v82
v_mul_f32 v91, v91, v83
v_cvt_pk_bf16_f32 v102, v91, v90
v_cvt_pk_bf16_f32 v103, v89, v88
v_lshlrev_b32 v76, 16, v68
v_and_b32 v77, 0xffff0000, v68
v_lshlrev_b32 v78, 16, v69
v_and_b32 v79, 0xffff0000, v69
v_lshlrev_b32 v80, 16, v18
v_lshlrev_b32 v81, 16, v22
v_lshlrev_b32 v82, 16, v26
v_lshlrev_b32 v83, 16, v30
v_lshlrev_b32 v84, 16, v34
v_lshlrev_b32 v85, 16, v38
v_lshlrev_b32 v86, 16, v42
v_mul_f32 v88, v79, v80
v_mul_f32 v89, v79, v81
v_mul_f32 v90, v79, v82
v_mul_f32 v91, v79, v83
v_fmac_f32 v88, v78, v81
v_fmac_f32 v89, v78, v82
v_fmac_f32 v90, v78, v83
v_fmac_f32 v91, v78, v84
v_fmac_f32 v88, v77, v82
v_fmac_f32 v89, v77, v83
v_fmac_f32 v90, v77, v84
v_fmac_f32 v91, v77, v85
v_fmac_f32 v88, v76, v83
v_fmac_f32 v89, v76, v84
v_fmac_f32 v90, v76, v85
v_fmac_f32 v91, v76, v86
v_lshlrev_b32 v80, 16, v46
v_lshlrev_b32 v81, 16, v50
v_lshlrev_b32 v82, 16, v54
v_lshlrev_b32 v83, 16, v58
v_mul_f32 v88, v88, v80
v_mul_f32 v89, v89, v81
v_mul_f32 v90, v90, v82
v_mul_f32 v91, v91, v83
v_cvt_pk_bf16_f32 v104, v91, v90
v_cvt_pk_bf16_f32 v105, v89, v88
v_lshlrev_b32 v76, 16, v70
v_and_b32 v77, 0xffff0000, v70
v_lshlrev_b32 v78, 16, v71
v_and_b32 v79, 0xffff0000, v71
v_and_b32 v80, 0xffff0000, v18
v_and_b32 v81, 0xffff0000, v22
v_and_b32 v82, 0xffff0000, v26
v_and_b32 v83, 0xffff0000, v30
v_and_b32 v84, 0xffff0000, v34
v_and_b32 v85, 0xffff0000, v38
v_and_b32 v86, 0xffff0000, v42
v_mul_f32 v88, v79, v80
v_mul_f32 v89, v79, v81
v_mul_f32 v90, v79, v82
v_mul_f32 v91, v79, v83
v_fmac_f32 v88, v78, v81
v_fmac_f32 v89, v78, v82
v_fmac_f32 v90, v78, v83
v_fmac_f32 v91, v78, v84
v_fmac_f32 v88, v77, v82
v_fmac_f32 v89, v77, v83
v_fmac_f32 v90, v77, v84
v_fmac_f32 v91, v77, v85
v_fmac_f32 v88, v76, v83
v_fmac_f32 v89, v76, v84
v_fmac_f32 v90, v76, v85
v_fmac_f32 v91, v76, v86
v_and_b32 v80, 0xffff0000, v46
v_and_b32 v81, 0xffff0000, v50
v_and_b32 v82, 0xffff0000, v54
v_and_b32 v83, 0xffff0000, v58
v_mul_f32 v88, v88, v80
v_mul_f32 v89, v89, v81
v_mul_f32 v90, v90, v82
v_mul_f32 v91, v91, v83
v_cvt_pk_bf16_f32 v106, v91, v90
v_cvt_pk_bf16_f32 v107, v89, v88
v_lshlrev_b32 v76, 16, v72
v_and_b32 v77, 0xffff0000, v72
v_lshlrev_b32 v78, 16, v73
v_and_b32 v79, 0xffff0000, v73
v_lshlrev_b32 v80, 16, v19
v_lshlrev_b32 v81, 16, v23
v_lshlrev_b32 v82, 16, v27
v_lshlrev_b32 v83, 16, v31
v_lshlrev_b32 v84, 16, v35
v_lshlrev_b32 v85, 16, v39
v_lshlrev_b32 v86, 16, v43
v_mul_f32 v88, v79, v80
v_mul_f32 v89, v79, v81
v_mul_f32 v90, v79, v82
v_mul_f32 v91, v79, v83
v_fmac_f32 v88, v78, v81
v_fmac_f32 v89, v78, v82
v_fmac_f32 v90, v78, v83
v_fmac_f32 v91, v78, v84
v_fmac_f32 v88, v77, v82
v_fmac_f32 v89, v77, v83
v_fmac_f32 v90, v77, v84
v_fmac_f32 v91, v77, v85
v_fmac_f32 v88, v76, v83
v_fmac_f32 v89, v76, v84
v_fmac_f32 v90, v76, v85
v_fmac_f32 v91, v76, v86
v_lshlrev_b32 v80, 16, v47
v_lshlrev_b32 v81, 16, v51
v_lshlrev_b32 v82, 16, v55
v_lshlrev_b32 v83, 16, v59
v_mul_f32 v88, v88, v80
v_mul_f32 v89, v89, v81
v_mul_f32 v90, v90, v82
v_mul_f32 v91, v91, v83
v_cvt_pk_bf16_f32 v108, v91, v90
v_cvt_pk_bf16_f32 v109, v89, v88
v_lshlrev_b32 v76, 16, v74
v_and_b32 v77, 0xffff0000, v74
v_lshlrev_b32 v78, 16, v75
v_and_b32 v79, 0xffff0000, v75
v_and_b32 v80, 0xffff0000, v19
v_and_b32 v81, 0xffff0000, v23
v_and_b32 v82, 0xffff0000, v27
v_and_b32 v83, 0xffff0000, v31
v_and_b32 v84, 0xffff0000, v35
v_and_b32 v85, 0xffff0000, v39
v_and_b32 v86, 0xffff0000, v43
v_mul_f32 v88, v79, v80
v_mul_f32 v89, v79, v81
v_mul_f32 v90, v79, v82
v_mul_f32 v91, v79, v83
v_fmac_f32 v88, v78, v81
v_fmac_f32 v89, v78, v82
v_fmac_f32 v90, v78, v83
v_fmac_f32 v91, v78, v84
v_fmac_f32 v88, v77, v82
v_fmac_f32 v89, v77, v83
v_fmac_f32 v90, v77, v84
v_fmac_f32 v91, v77, v85
v_fmac_f32 v88, v76, v83
v_fmac_f32 v89, v76, v84
v_fmac_f32 v90, v76, v85
v_fmac_f32 v91, v76, v86
v_and_b32 v80, 0xffff0000, v47
v_and_b32 v81, 0xffff0000, v51
v_and_b32 v82, 0xffff0000, v55
v_and_b32 v83, 0xffff0000, v59
v_mul_f32 v88, v88, v80
v_mul_f32 v89, v89, v81
v_mul_f32 v90, v90, v82
v_mul_f32 v91, v91, v83
v_cvt_pk_bf16_f32 v110, v91, v90
v_cvt_pk_bf16_f32 v111, v89, v88
v_cmp_gt_u32 vcc, 56, v0
s_and_saveexec_b64 s[34:35], vcc
ds_write_b64 v9, v[96:97] offset:0
ds_write_b64 v9, v[98:99] offset:128
ds_write_b64 v9, v[100:101] offset:256
ds_write_b64 v9, v[102:103] offset:384
ds_write_b64 v9, v[104:105] offset:512
ds_write_b64 v9, v[106:107] offset:640
ds_write_b64 v9, v[108:109] offset:768
ds_write_b64 v9, v[110:111] offset:896
s_mov_b64 exec, s[34:35]
s_mul_i32 s62, s4, 28
v_lshrrev_b32 v12, 3, v0
v_add_u32 v12, s62, v12
v_and_b32 v11, 7, v0
v_add_u32 v13, 0, v12
v_bfe_u32 v14, v13, 3, 3
v_xor_b32 v14, v14, v11
v_lshlrev_b32 v14, 4, v14
v_lshl_add_u32 v20, v13, 7, v14
v_add_u32 v13, 7, v12
v_bfe_u32 v14, v13, 3, 3
v_xor_b32 v14, v14, v11
v_lshlrev_b32 v14, 4, v14
v_lshl_add_u32 v21, v13, 7, v14
v_add_u32 v13, 14, v12
v_bfe_u32 v14, v13, 3, 3
v_xor_b32 v14, v14, v11
v_lshlrev_b32 v14, 4, v14
v_lshl_add_u32 v22, v13, 7, v14
v_add_u32 v13, 21, v12
v_bfe_u32 v14, v13, 3, 3
v_xor_b32 v14, v14, v11
v_lshlrev_b32 v14, 4, v14
v_lshl_add_u32 v23, v13, 7, v14
s_mul_i32 s33, s5, 224
v_add_u32 v12, s33, v12
v_lshlrev_b32 v12, 12, v12
v_lshl_add_u32 v12, v11, 4, v12
s_lshl_b32 s33, s6, 7
s_sub_u32 s33, 6295424, s33
s_waitcnt lgkmcnt(0)
s_barrier
s_and_saveexec_b64 s[34:35], vcc
ds_read_b128 v[24:27], v20
ds_read_b128 v[28:31], v21
ds_read_b128 v[32:35], v22
ds_read_b128 v[36:39], v23
s_waitcnt lgkmcnt(0)
buffer_store_dwordx4 v[24:27], v12, s[16:19], s33 offen sc1
s_add_u32 s33, s33, 28672
buffer_store_dwordx4 v[28:31], v12, s[16:19], s33 offen sc1
s_add_u32 s33, s33, 28672
buffer_store_dwordx4 v[32:35], v12, s[16:19], s33 offen sc1
s_add_u32 s33, s33, 28672
buffer_store_dwordx4 v[36:39], v12, s[16:19], s33 offen sc1
s_mov_b64 exec, s[34:35]
s_waitcnt lgkmcnt(0)
s_mul_i32 s64, s64, 0x9E3779B1
s_add_u32 s64, s64, 0x7F4A7C15
s_or_b32 s64, s64, 1
v_lshlrev_b32 v1, 4, v0
s_waitcnt vmcnt(0) lgkmcnt(0)
s_barrier
s_cmp_lg_u32 s4, 0
s_cbranch_scc1 gated_mix__softmax_full_mha__ssm_conv_h3__prompt_kernel_side_np
v_mov_b32 v250, s64
v_lshlrev_b32 v251, 7, v0
s_mov_b64 s[66:67], exec
s_mov_b64 exec, 0xff
buffer_store_dword v250, v251, s[16:19], s69 offen sc1
s_mov_b64 exec, s[66:67]
s_mov_b64 s[20:21], s[58:59]
s_mov_b32 s22, 0x100
s_mov_b32 s23, 0x20000
v_mov_b32 v250, 1
v_mov_b32 v251, 0
s_mov_b64 s[66:67], exec
s_mov_b64 exec, 1
buffer_atomic_add v250, v251, s[20:23], 0 offen sc1
s_mov_b64 exec, s[66:67]
gated_mix__softmax_full_mha__ssm_conv_h3__prompt_kernel_side_np:
s_cmp_ge_u32 s4, 4
s_cbranch_scc1 gated_mix__softmax_full_mha__ssm_conv_h3__prompt_kernel_prep_h
s_branch gated_mix__softmax_full_mha__ssm_conv_h3__prompt_kernel_cwait1
gated_mix__softmax_full_mha__ssm_conv_h3__prompt_kernel_prep0:
s_cmp_ge_u32 s2, 224
s_cbranch_scc1 gated_mix__softmax_full_mha__ssm_conv_h3__prompt_kernel_attn_noconv
s_sub_u32 s26, s4, 4
s_lshl_b32 s27, s2, 13
s_lshl_b32 s34, s26, 10
v_add_u32 v12, s34, v1
v_subrev_u32 v13, 32, v1
v_subrev_u32 v14, 16, v1
s_add_u32 s28, s50, s27
s_addc_u32 s29, s51, 0
s_mov_b64 s[92:93], s[28:29]
s_mov_b32 s94, 4096
s_mov_b32 s95, 0x20000
buffer_load_dwordx4 v[192:195], v12, s[92:95], 0 offen
buffer_load_dwordx2 v[196:197], v12, s[92:95], 0 offen offset:16
buffer_load_dwordx4 v[200:203], v13, s[92:95], 0 offen
buffer_load_dwordx2 v[204:205], v14, s[92:95], 0 offen
s_add_u32 s28, s50, s27
s_addc_u32 s29, s51, 0
s_add_u32 s28, s28, 4096
s_addc_u32 s29, s29, 0
s_mov_b64 s[92:93], s[28:29]
s_mov_b32 s94, 4096
s_mov_b32 s95, 0x20000
buffer_load_dwordx4 v[208:211], v12, s[92:95], 0 offen
buffer_load_dwordx2 v[212:213], v12, s[92:95], 0 offen offset:16
buffer_load_dwordx4 v[216:219], v13, s[92:95], 0 offen
buffer_load_dwordx2 v[220:221], v14, s[92:95], 0 offen
gated_mix__softmax_full_mha__ssm_conv_h3__prompt_kernel_prep_h:
s_sub_u32 s26, s4, 4
s_lshl_b32 s27, s2, 13
s_lshl_b32 s34, s26, 10
v_add_u32 v2, s34, v1
v_mov_b32 v32, 0
v_mov_b32 v33, 0
v_mov_b32 v34, 0
v_mov_b32 v35, 0
v_add_u32 v5, 86272, v1
v_cmp_gt_u32 vcc, 30, v0
s_and_saveexec_b64 s[62:63], vcc
ds_write_b128 v5, v[32:35]
ds_write_b128 v5, v[32:35] offset:21248
s_mov_b64 exec, s[62:63]
v_add_u32 v6, 65568, v2
s_waitcnt vmcnt(0)
ds_write_b128 v6, v[192:195] offset:0
v_alignbit_b32 v36, v193, v192, 16
v_alignbit_b32 v37, v194, v193, 16
v_alignbit_b32 v38, v195, v194, 16
v_alignbit_b32 v39, v196, v195, 16
ds_write_b128 v6, v[36:39] offset:4160
v_mov_b32 v40, v193
v_mov_b32 v41, v194
v_mov_b32 v42, v195
v_mov_b32 v43, v196
ds_write_b128 v6, v[40:43] offset:8320
v_alignbit_b32 v44, v194, v193, 16
v_alignbit_b32 v45, v195, v194, 16
v_alignbit_b32 v46, v196, v195, 16
v_alignbit_b32 v47, v197, v196, 16
ds_write_b128 v6, v[44:47] offset:12480
ds_write_b128 v6, v[208:211] offset:21248
v_alignbit_b32 v36, v209, v208, 16
v_alignbit_b32 v37, v210, v209, 16
v_alignbit_b32 v38, v211, v210, 16
v_alignbit_b32 v39, v212, v211, 16
ds_write_b128 v6, v[36:39] offset:25408
v_mov_b32 v40, v209
v_mov_b32 v41, v210
v_mov_b32 v42, v211
v_mov_b32 v43, v212
ds_write_b128 v6, v[40:43] offset:29568
v_alignbit_b32 v44, v210, v209, 16
v_alignbit_b32 v45, v211, v210, 16
v_alignbit_b32 v46, v212, v211, 16
v_alignbit_b32 v47, v213, v212, 16
ds_write_b128 v6, v[44:47] offset:33728
s_cmp_lg_u32 s26, 0
s_cbranch_scc1 gated_mix__softmax_full_mha__ssm_conv_h3__prompt_kernel_prep_noleadg
v_add_u32 v6, 65536, v1
v_cmp_gt_u32 vcc, 2, v0
s_and_saveexec_b64 s[62:63], vcc
ds_write_b128 v6, v[200:203] offset:0
v_alignbit_b32 v36, v201, v200, 16
v_alignbit_b32 v37, v202, v201, 16
v_alignbit_b32 v38, v203, v202, 16
v_alignbit_b32 v39, v204, v203, 16
ds_write_b128 v6, v[36:39] offset:4160
v_mov_b32 v40, v201
v_mov_b32 v41, v202
v_mov_b32 v42, v203
v_mov_b32 v43, v204
ds_write_b128 v6, v[40:43] offset:8320
v_alignbit_b32 v44, v202, v201, 16
v_alignbit_b32 v45, v203, v202, 16
v_alignbit_b32 v46, v204, v203, 16
v_alignbit_b32 v47, v205, v204, 16
ds_write_b128 v6, v[44:47] offset:12480
ds_write_b128 v6, v[216:219] offset:21248
v_alignbit_b32 v36, v217, v216, 16
v_alignbit_b32 v37, v218, v217, 16
v_alignbit_b32 v38, v219, v218, 16
v_alignbit_b32 v39, v220, v219, 16
ds_write_b128 v6, v[36:39] offset:25408
v_mov_b32 v40, v217
v_mov_b32 v41, v218
v_mov_b32 v42, v219
v_mov_b32 v43, v220
ds_write_b128 v6, v[40:43] offset:29568
v_alignbit_b32 v44, v218, v217, 16
v_alignbit_b32 v45, v219, v218, 16
v_alignbit_b32 v46, v220, v219, 16
v_alignbit_b32 v47, v221, v220, 16
ds_write_b128 v6, v[44:47] offset:33728
s_mov_b64 exec, s[62:63]
gated_mix__softmax_full_mha__ssm_conv_h3__prompt_kernel_prep_noleadg:
gated_mix__softmax_full_mha__ssm_conv_h3__prompt_kernel_prep_u:
s_lshl_b32 s27, s2, 13
s_cmp_lg_u32 s4, 4
s_cbranch_scc1 nou_5
s_cmp_ge_u32 s2, 112
s_movk_i32 s62, 1024
s_cselect_b32 s62, s62, 0
s_and_b32 s63, s2, 7
s_lshl_b32 s63, s63, 7
s_add_u32 s62, s62, s63
s_add_u32 s62, s62, 14692352
v_and_b32 v253, 31, v0
v_lshlrev_b32 v253, 2, v253
s_mov_b32 s68, 40000
sp_6:
buffer_load_dword v252, v253, s[16:19], s62 offen sc1
s_sub_u32 s68, s68, 1
s_waitcnt vmcnt(0)
v_cmp_ne_u32 vcc, s64, v252
s_cmp_eq_u32 s68, 0
s_cbranch_scc1 sd_7
s_cbranch_vccnz sp_6
sd_7:
s_add_u32 s63, s27, 6291456
s_mov_b32 m0, 82176
s_nop 0
buffer_load_dwordx4 v1, s[16:19], s63 offen offset:0 sc1 lds
buffer_load_dwordx4 v1, s[16:19], s63 offen offset:1024 sc1 lds
buffer_load_dwordx4 v1, s[16:19], s63 offen offset:2048 sc1 lds
buffer_load_dwordx4 v1, s[16:19], s63 offen offset:3072 sc1 lds
s_add_u32 s63, s27, 6295552
s_mov_b32 m0, 103424
s_nop 0
buffer_load_dwordx4 v1, s[16:19], s63 offen offset:0 sc1 lds
buffer_load_dwordx4 v1, s[16:19], s63 offen offset:1024 sc1 lds
buffer_load_dwordx4 v1, s[16:19], s63 offen offset:2048 sc1 lds
buffer_load_dwordx4 v1, s[16:19], s63 offen offset:3072 sc1 lds
nou_5:
s_waitcnt vmcnt(0) lgkmcnt(0)
s_branch gated_mix__softmax_full_mha__ssm_conv_h3__prompt_kernel_cwait
gated_mix__softmax_full_mha__ssm_conv_h3__prompt_kernel_cwait1:
s_mov_b64 s[12:13], s[54:55]
s_mov_b32 s14, 0x380
s_mov_b32 s15, 0x20000
s_and_b32 s33, s2, 7
s_lshl_b32 s33, s33, 3
s_bfe_u32 s62, s2, 0x30003
s_add_u32 s33, s33, s62
s_lshl_b32 s33, s33, 5
s_mul_i32 s62, s4, 8
s_add_u32 s33, s33, s62
v_lshrrev_b32 v132, 5, v0
v_add_u32 v132, s33, v132
v_mul_u32_u24 v132, 896, v132
v_and_b32 v133, 31, v0
v_mul_u32_u24 v133, 28, v133
v_add_u32 v132, v132, v133
v_add_u32 v134, 3584, v132
buffer_load_dwordx4 v[168:171], v133, s[12:15], 0 offen
buffer_load_dwordx3 v[172:174], v133, s[12:15], 0 offen offset:16
buffer_load_dwordx4 v[136:139], v132, s[8:11], 0 offen offset:0
buffer_load_dwordx3 v[140:142], v132, s[8:11], 0 offen offset:16
buffer_load_dwordx4 v[144:147], v132, s[8:11], 0 offen offset:1792
buffer_load_dwordx3 v[148:150], v132, s[8:11], 0 offen offset:1808
buffer_load_dwordx4 v[152:155], v134, s[8:11], 0 offen offset:0
buffer_load_dwordx3 v[156:158], v134, s[8:11], 0 offen offset:16
buffer_load_dwordx4 v[160:163], v134, s[8:11], 0 offen offset:1792
buffer_load_dwordx3 v[164:166], v134, s[8:11], 0 offen offset:1808
s_waitcnt vmcnt(0)
gated_mix__softmax_full_mha__ssm_conv_h3__prompt_kernel_cwait2:
v_mov_b32 v176, 0
v_mov_b32 v177, 0
v_mov_b32 v184, 0
v_mov_b32 v185, 0
v_mov_b32 v192, 0
v_mov_b32 v193, 0
v_mov_b32 v200, 0
v_mov_b32 v201, 0
v_lshlrev_b32 v208, 16, v168
v_and_b32 v209, 0xffff0000, v168
v_lshlrev_b32 v178, 16, v136
v_and_b32 v179, 0xffff0000, v136
v_lshlrev_b32 v186, 16, v144
v_and_b32 v187, 0xffff0000, v144
v_lshlrev_b32 v194, 16, v152
v_and_b32 v195, 0xffff0000, v152
v_lshlrev_b32 v202, 16, v160
v_and_b32 v203, 0xffff0000, v160
v_mul_f32 v178, v178, v208
v_mul_f32 v179, v179, v209
v_mul_f32 v186, v186, v208
v_mul_f32 v187, v187, v209
v_mul_f32 v194, v194, v208
v_mul_f32 v195, v195, v209
v_mul_f32 v202, v202, v208
v_mul_f32 v203, v203, v209
v_cvt_pk_bf16_f32 v178, v178, v179
v_cvt_pk_bf16_f32 v186, v186, v187
v_cvt_pk_bf16_f32 v194, v194, v195
v_cvt_pk_bf16_f32 v202, v202, v203
v_lshlrev_b32 v179, 16, v178
v_and_b32 v178, 0xffff0000, v178
v_lshlrev_b32 v187, 16, v186
v_and_b32 v186, 0xffff0000, v186
v_lshlrev_b32 v195, 16, v194
v_and_b32 v194, 0xffff0000, v194
v_lshlrev_b32 v203, 16, v202
v_and_b32 v202, 0xffff0000, v202
v_add_f32 v176, v176, v179
v_add_f32 v177, v177, v178
v_add_f32 v184, v184, v187
v_add_f32 v185, v185, v186
v_add_f32 v192, v192, v195
v_add_f32 v193, v193, v194
v_add_f32 v200, v200, v203
v_add_f32 v201, v201, v202
v_lshlrev_b32 v208, 16, v169
v_and_b32 v209, 0xffff0000, v169
v_lshlrev_b32 v178, 16, v137
v_and_b32 v179, 0xffff0000, v137
v_lshlrev_b32 v186, 16, v145
v_and_b32 v187, 0xffff0000, v145
v_lshlrev_b32 v194, 16, v153
v_and_b32 v195, 0xffff0000, v153
v_lshlrev_b32 v202, 16, v161
v_and_b32 v203, 0xffff0000, v161
v_mul_f32 v178, v178, v208
v_mul_f32 v179, v179, v209
v_mul_f32 v186, v186, v208
v_mul_f32 v187, v187, v209
v_mul_f32 v194, v194, v208
v_mul_f32 v195, v195, v209
v_mul_f32 v202, v202, v208
v_mul_f32 v203, v203, v209
v_cvt_pk_bf16_f32 v178, v178, v179
v_cvt_pk_bf16_f32 v186, v186, v187
v_cvt_pk_bf16_f32 v194, v194, v195
v_cvt_pk_bf16_f32 v202, v202, v203
v_lshlrev_b32 v179, 16, v178
v_and_b32 v178, 0xffff0000, v178
v_lshlrev_b32 v187, 16, v186
v_and_b32 v186, 0xffff0000, v186
v_lshlrev_b32 v195, 16, v194
v_and_b32 v194, 0xffff0000, v194
v_lshlrev_b32 v203, 16, v202
v_and_b32 v202, 0xffff0000, v202
v_add_f32 v176, v176, v179
v_add_f32 v177, v177, v178
v_add_f32 v184, v184, v187
v_add_f32 v185, v185, v186
v_add_f32 v192, v192, v195
v_add_f32 v193, v193, v194
v_add_f32 v200, v200, v203
v_add_f32 v201, v201, v202
v_lshlrev_b32 v208, 16, v170
v_and_b32 v209, 0xffff0000, v170
v_lshlrev_b32 v178, 16, v138
v_and_b32 v179, 0xffff0000, v138
v_lshlrev_b32 v186, 16, v146
v_and_b32 v187, 0xffff0000, v146
v_lshlrev_b32 v194, 16, v154
v_and_b32 v195, 0xffff0000, v154
v_lshlrev_b32 v202, 16, v162
v_and_b32 v203, 0xffff0000, v162
v_mul_f32 v178, v178, v208
v_mul_f32 v179, v179, v209
v_mul_f32 v186, v186, v208
v_mul_f32 v187, v187, v209
v_mul_f32 v194, v194, v208
v_mul_f32 v195, v195, v209
v_mul_f32 v202, v202, v208
v_mul_f32 v203, v203, v209
v_cvt_pk_bf16_f32 v178, v178, v179
v_cvt_pk_bf16_f32 v186, v186, v187
v_cvt_pk_bf16_f32 v194, v194, v195
v_cvt_pk_bf16_f32 v202, v202, v203
v_lshlrev_b32 v179, 16, v178
v_and_b32 v178, 0xffff0000, v178
v_lshlrev_b32 v187, 16, v186
v_and_b32 v186, 0xffff0000, v186
v_lshlrev_b32 v195, 16, v194
v_and_b32 v194, 0xffff0000, v194
v_lshlrev_b32 v203, 16, v202
v_and_b32 v202, 0xffff0000, v202
v_add_f32 v176, v176, v179
v_add_f32 v177, v177, v178
v_add_f32 v184, v184, v187
v_add_f32 v185, v185, v186
v_add_f32 v192, v192, v195
v_add_f32 v193, v193, v194
v_add_f32 v200, v200, v203
v_add_f32 v201, v201, v202
v_lshlrev_b32 v208, 16, v171
v_and_b32 v209, 0xffff0000, v171
v_lshlrev_b32 v178, 16, v139
v_and_b32 v179, 0xffff0000, v139
v_lshlrev_b32 v186, 16, v147
v_and_b32 v187, 0xffff0000, v147
v_lshlrev_b32 v194, 16, v155
v_and_b32 v195, 0xffff0000, v155
v_lshlrev_b32 v202, 16, v163
v_and_b32 v203, 0xffff0000, v163
v_mul_f32 v178, v178, v208
v_mul_f32 v179, v179, v209
v_mul_f32 v186, v186, v208
v_mul_f32 v187, v187, v209
v_mul_f32 v194, v194, v208
v_mul_f32 v195, v195, v209
v_mul_f32 v202, v202, v208
v_mul_f32 v203, v203, v209
v_cvt_pk_bf16_f32 v178, v178, v179
v_cvt_pk_bf16_f32 v186, v186, v187
v_cvt_pk_bf16_f32 v194, v194, v195
v_cvt_pk_bf16_f32 v202, v202, v203
v_lshlrev_b32 v179, 16, v178
v_and_b32 v178, 0xffff0000, v178
v_lshlrev_b32 v187, 16, v186
v_and_b32 v186, 0xffff0000, v186
v_lshlrev_b32 v195, 16, v194
v_and_b32 v194, 0xffff0000, v194
v_lshlrev_b32 v203, 16, v202
v_and_b32 v202, 0xffff0000, v202
v_add_f32 v176, v176, v179
v_add_f32 v177, v177, v178
v_add_f32 v184, v184, v187
v_add_f32 v185, v185, v186
v_add_f32 v192, v192, v195
v_add_f32 v193, v193, v194
v_add_f32 v200, v200, v203
v_add_f32 v201, v201, v202
v_lshlrev_b32 v208, 16, v172
v_and_b32 v209, 0xffff0000, v172
v_lshlrev_b32 v178, 16, v140
v_and_b32 v179, 0xffff0000, v140
v_lshlrev_b32 v186, 16, v148
v_and_b32 v187, 0xffff0000, v148
v_lshlrev_b32 v194, 16, v156
v_and_b32 v195, 0xffff0000, v156
v_lshlrev_b32 v202, 16, v164
v_and_b32 v203, 0xffff0000, v164
v_mul_f32 v178, v178, v208
v_mul_f32 v179, v179, v209
v_mul_f32 v186, v186, v208
v_mul_f32 v187, v187, v209
v_mul_f32 v194, v194, v208
v_mul_f32 v195, v195, v209
v_mul_f32 v202, v202, v208
v_mul_f32 v203, v203, v209
v_cvt_pk_bf16_f32 v178, v178, v179
v_cvt_pk_bf16_f32 v186, v186, v187
v_cvt_pk_bf16_f32 v194, v194, v195
v_cvt_pk_bf16_f32 v202, v202, v203
v_lshlrev_b32 v179, 16, v178
v_and_b32 v178, 0xffff0000, v178
v_lshlrev_b32 v187, 16, v186
v_and_b32 v186, 0xffff0000, v186
v_lshlrev_b32 v195, 16, v194
v_and_b32 v194, 0xffff0000, v194
v_lshlrev_b32 v203, 16, v202
v_and_b32 v202, 0xffff0000, v202
v_add_f32 v176, v176, v179
v_add_f32 v177, v177, v178
v_add_f32 v184, v184, v187
v_add_f32 v185, v185, v186
v_add_f32 v192, v192, v195
v_add_f32 v193, v193, v194
v_add_f32 v200, v200, v203
v_add_f32 v201, v201, v202
v_lshlrev_b32 v208, 16, v173
v_and_b32 v209, 0xffff0000, v173
v_lshlrev_b32 v178, 16, v141
v_and_b32 v179, 0xffff0000, v141
v_lshlrev_b32 v186, 16, v149
v_and_b32 v187, 0xffff0000, v149
v_lshlrev_b32 v194, 16, v157
v_and_b32 v195, 0xffff0000, v157
v_lshlrev_b32 v202, 16, v165
v_and_b32 v203, 0xffff0000, v165
v_mul_f32 v178, v178, v208
v_mul_f32 v179, v179, v209
v_mul_f32 v186, v186, v208
v_mul_f32 v187, v187, v209
v_mul_f32 v194, v194, v208
v_mul_f32 v195, v195, v209
v_mul_f32 v202, v202, v208
v_mul_f32 v203, v203, v209
v_cvt_pk_bf16_f32 v178, v178, v179
v_cvt_pk_bf16_f32 v186, v186, v187
v_cvt_pk_bf16_f32 v194, v194, v195
v_cvt_pk_bf16_f32 v202, v202, v203
v_lshlrev_b32 v179, 16, v178
v_and_b32 v178, 0xffff0000, v178
v_lshlrev_b32 v187, 16, v186
v_and_b32 v186, 0xffff0000, v186
v_lshlrev_b32 v195, 16, v194
v_and_b32 v194, 0xffff0000, v194
v_lshlrev_b32 v203, 16, v202
v_and_b32 v202, 0xffff0000, v202
v_add_f32 v176, v176, v179
v_add_f32 v177, v177, v178
v_add_f32 v184, v184, v187
v_add_f32 v185, v185, v186
v_add_f32 v192, v192, v195
v_add_f32 v193, v193, v194
v_add_f32 v200, v200, v203
v_add_f32 v201, v201, v202
v_lshlrev_b32 v208, 16, v174
v_and_b32 v209, 0xffff0000, v174
v_lshlrev_b32 v178, 16, v142
v_and_b32 v179, 0xffff0000, v142
v_lshlrev_b32 v186, 16, v150
v_and_b32 v187, 0xffff0000, v150
v_lshlrev_b32 v194, 16, v158
v_and_b32 v195, 0xffff0000, v158
v_lshlrev_b32 v202, 16, v166
v_and_b32 v203, 0xffff0000, v166
v_mul_f32 v178, v178, v208
v_mul_f32 v179, v179, v209
v_mul_f32 v186, v186, v208
v_mul_f32 v187, v187, v209
v_mul_f32 v194, v194, v208
v_mul_f32 v195, v195, v209
v_mul_f32 v202, v202, v208
v_mul_f32 v203, v203, v209
v_cvt_pk_bf16_f32 v178, v178, v179
v_cvt_pk_bf16_f32 v186, v186, v187
v_cvt_pk_bf16_f32 v194, v194, v195
v_cvt_pk_bf16_f32 v202, v202, v203
v_lshlrev_b32 v179, 16, v178
v_and_b32 v178, 0xffff0000, v178
v_lshlrev_b32 v187, 16, v186
v_and_b32 v186, 0xffff0000, v186
v_lshlrev_b32 v195, 16, v194
v_and_b32 v194, 0xffff0000, v194
v_lshlrev_b32 v203, 16, v202
v_and_b32 v202, 0xffff0000, v202
v_add_f32 v176, v176, v179
v_add_f32 v177, v177, v178
v_add_f32 v184, v184, v187
v_add_f32 v185, v185, v186
v_add_f32 v192, v192, v195
v_add_f32 v193, v193, v194
v_add_f32 v200, v200, v203
v_add_f32 v201, v201, v202
v_add_f32 v176, v176, v177
v_add_f32 v184, v184, v185
v_add_f32 v192, v192, v193
v_add_f32 v200, v200, v201
v_add_f32_dpp v176, v176, v176 row_shr:1 row_mask:0xf bank_mask:0xf bound_ctrl:0
v_add_f32_dpp v184, v184, v184 row_shr:1 row_mask:0xf bank_mask:0xf bound_ctrl:0
v_add_f32_dpp v192, v192, v192 row_shr:1 row_mask:0xf bank_mask:0xf bound_ctrl:0
v_add_f32_dpp v200, v200, v200 row_shr:1 row_mask:0xf bank_mask:0xf bound_ctrl:0
v_add_f32_dpp v176, v176, v176 row_shr:2 row_mask:0xf bank_mask:0xf bound_ctrl:0
v_add_f32_dpp v184, v184, v184 row_shr:2 row_mask:0xf bank_mask:0xf bound_ctrl:0
v_add_f32_dpp v192, v192, v192 row_shr:2 row_mask:0xf bank_mask:0xf bound_ctrl:0
v_add_f32_dpp v200, v200, v200 row_shr:2 row_mask:0xf bank_mask:0xf bound_ctrl:0
v_add_f32_dpp v176, v176, v176 row_shr:4 row_mask:0xf bank_mask:0xf bound_ctrl:0
v_add_f32_dpp v184, v184, v184 row_shr:4 row_mask:0xf bank_mask:0xf bound_ctrl:0
v_add_f32_dpp v192, v192, v192 row_shr:4 row_mask:0xf bank_mask:0xf bound_ctrl:0
v_add_f32_dpp v200, v200, v200 row_shr:4 row_mask:0xf bank_mask:0xf bound_ctrl:0
v_add_f32_dpp v176, v176, v176 row_shr:8 row_mask:0xf bank_mask:0xf bound_ctrl:0
v_add_f32_dpp v184, v184, v184 row_shr:8 row_mask:0xf bank_mask:0xf bound_ctrl:0
v_add_f32_dpp v192, v192, v192 row_shr:8 row_mask:0xf bank_mask:0xf bound_ctrl:0
v_add_f32_dpp v200, v200, v200 row_shr:8 row_mask:0xf bank_mask:0xf bound_ctrl:0
v_add_f32_dpp v176, v176, v176 row_bcast:15 row_mask:0xa bank_mask:0xf
v_add_f32_dpp v184, v184, v184 row_bcast:15 row_mask:0xa bank_mask:0xf
v_add_f32_dpp v192, v192, v192 row_bcast:15 row_mask:0xa bank_mask:0xf
v_add_f32_dpp v200, v200, v200 row_bcast:15 row_mask:0xa bank_mask:0xf
v_cvt_pk_bf16_f32 v177, v176, v176
v_cvt_pk_bf16_f32 v185, v184, v184
v_cvt_pk_bf16_f32 v193, v192, v192
v_cvt_pk_bf16_f32 v201, v200, v200
v_lshlrev_b32 v177, 16, v177
v_lshlrev_b32 v185, 16, v185
v_lshlrev_b32 v193, 16, v193
v_lshlrev_b32 v201, 16, v201
v_mul_f32 v177, 0xbfb8aa3b, v177
v_mul_f32 v185, 0xbfb8aa3b, v185
v_mul_f32 v193, 0xbfb8aa3b, v193
v_mul_f32 v201, 0xbfb8aa3b, v201
v_exp_f32 v177, v177
v_exp_f32 v185, v185
v_exp_f32 v193, v193
v_exp_f32 v201, v201
v_add_f32 v177, 1.0, v177
v_add_f32 v185, 1.0, v185
v_add_f32 v193, 1.0, v193
v_add_f32 v201, 1.0, v201
v_rcp_f32 v177, v177
v_rcp_f32 v185, v185
v_rcp_f32 v193, v193
v_rcp_f32 v201, v201
v_cvt_pk_bf16_f32 v177, v177, v177
v_cvt_pk_bf16_f32 v185, v185, v185
v_cvt_pk_bf16_f32 v193, v193, v193
v_cvt_pk_bf16_f32 v201, v201, v201
v_lshlrev_b32 v177, 16, v177
v_lshlrev_b32 v185, 16, v185
v_lshlrev_b32 v193, 16, v193
v_lshlrev_b32 v201, 16, v201
s_mul_i32 s62, s4, 32
s_add_u32 s62, s62, 147520
v_lshrrev_b32 v210, 5, v0
v_lshlrev_b32 v210, 2, v210
v_add_u32 v210, s62, v210
v_and_b32 v211, 31, v0
v_cmp_eq_u32 vcc, 31, v211
s_and_saveexec_b64 s[66:67], vcc
ds_write_b32 v210, v177 offset:0
ds_write_b32 v210, v185 offset:8
ds_write_b32 v210, v193 offset:16
ds_write_b32 v210, v201 offset:24
s_mov_b64 exec, s[66:67]
s_waitcnt lgkmcnt(0)
gated_mix__softmax_full_mha__ssm_conv_h3__prompt_kernel_cwait3:
s_cmp_ge_u32 s2, 224
s_cbranch_scc1 gated_mix__softmax_full_mha__ssm_conv_h3__prompt_kernel_attn_noconv
gated_mix__softmax_full_mha__ssm_conv_h3__prompt_kernel_cwait:
v_lshlrev_b32 v1, 4, v0
s_lshr_b32 s7, s4, 2
s_lshl_b32 s24, s2, 1
s_add_u32 s24, s24, s7
s_mul_i32 s25, s7, 21248
s_add_u32 s25, s25, 65536
s_lshl_b32 s27, s24, 12
s_lshl_b32 s32, s2, 2
s_load_dword s33, s[52:53], s32
v_and_b32 v2, 15, v0
v_lshrrev_b32 v3, 4, v0
v_add_u32 v4, 1, v2
v_and_b32 v5, 3, v4
v_sub_u32 v4, v4, v5
v_lshl_add_u32 v4, v3, 3, v4
v_lshlrev_b32 v4, 1, v4
v_mul_u32_u24 v5, 4160, v5
v_add_u32 v4, v4, v5
s_bfe_u32 s34, s4, 0x10001
s_lshl_b32 s35, s34, 8
s_add_u32 s65, s35, s25
v_add_u32 v6, s65, v4
v_lshlrev_b32 v4, 5, v2
v_lshlrev_b32 v5, 4, v3
v_sub_u32 v4, v5, v4
s_add_u32 s65, s65, 17120
v_add_u32 v7, s65, v4
s_and_b32 s65, s4, 1
gated_mix__softmax_full_mha__ssm_conv_h3__prompt_kernel_attn_noconv:
s_lshl_b32 s5, s3, 1
s_bfe_u32 s7, s2, 0x10003
s_add_u32 s5, s5, s7
s_lshr_b32 s6, s2, 4
s_mov_b32 s70, 0
v_mov_b32 v100, 147456
v_mov_b32 v101, 0
ds_write_b32 v100, v101
v_and_b32 v100, 31, v0
v_lshlrev_b32 v100, 2, v100
v_add_u32 v100, 147712, v100
ds_write_b32 v100, v101
s_mov_b64 s[8:9], s[40:41]
s_mov_b32 s10, 0x62000
s_mov_b32 s11, 0x20000
s_lshr_b32 s96, s2, 6
s_mul_i32 s96, s96, 224
v_bfe_u32 v180, v0, 2, 2
v_mul_u32_u24 v180, 896, v180
v_lshrrev_b32 v102, 4, v0
v_lshl_add_u32 v180, v102, 6, v180
v_and_b32 v102, 3, v0
v_lshl_add_u32 v180, v102, 4, v180
s_lshr_b32 s7, s4, 2
s_lshl_b32 s69, s2, 1
s_add_u32 s69, s69, s7
s_lshl_b32 s69, s69, 2
s_add_u32 s69, s69, 14696448
s_lshl_b32 s97, s4, 12
s_cmp_lt_u32 s2, 224
s_cselect_b32 s71, 1, 0
s_and_b32 s7, s4, 3
s_cmp_eq_u32 s7, 0
s_cselect_b32 s71, s71, 0
s_lshl_b32 s7, s5, 6
s_lshl_b32 s62, s6, 2
s_add_u32 s7, s7, s62
s_and_b32 s62, s4, 3
s_add_u32 s7, s7, s62
s_lshl_b32 s7, s7, 11
s_add_u32 s98, s7, 0
s_lshl_b32 s20, s5, 6
s_lshr_b32 s7, s4, 2
s_lshl_b32 s7, s7, 5
s_add_u32 s20, s20, s7
s_and_b32 s7, s4, 3
s_add_u32 s20, s20, s7
s_lshl_b32 s20, s20, 12
s_add_u32 s20, s20, 2097152
s_lshl_b32 s21, s4, 12
s_and_b32 s99, s6, 7
s_lshl_b32 s7, s99, 14
s_add_u32 s20, s20, s7
s_cmp_lg_u32 s4, 0
s_cbranch_scc1 np_8
s_lshr_b32 s62, s5, 2
s_mul_i32 s62, s62, 12
s_bfe_u32 s63, s5, 0x10001
s_lshl_b32 s63, s63, 1
s_add_u32 s62, s62, s63
s_lshl_b32 s62, s62, 7
s_add_u32 s62, s62, 14684160
v_lshrrev_b32 v253, 5, v0
v_add_u32 v253, 1, v253
v_lshlrev_b32 v253, 9, v253
v_bfe_u32 v254, v0, 4, 1
v_lshl_add_u32 v253, v254, 7, v253
v_and_b32 v254, 15, v0
v_lshl_add_u32 v253, v254, 2, v253
v_and_b32 v254, 1, v0
v_lshlrev_b32 v254, 7, v254
s_lshl_b32 s63, s6, 2
v_add_u32 v254, s63, v254
v_mov_b32 v255, v254
s_mov_b32 s68, 40000
fap_9:
buffer_load_dword v252, v253, s[16:19], s62 offen sc1
buffer_load_dword v254, v255, s[16:19], s62 offen sc1
s_sub_u32 s68, s68, 1
s_waitcnt vmcnt(0)
v_cmp_ne_u32 vcc, s64, v252
v_cmp_ne_u32 s[66:67], s64, v254
s_or_b64 vcc, vcc, s[66:67]
s_cmp_eq_u32 s68, 0
s_cbranch_scc1 fad_10
s_cbranch_vccnz fap_9
fad_10:
np_8:
s_waitcnt lgkmcnt(0)
s_barrier
s_cmp_lt_u32 s2, 224
s_cbranch_scc1 gated_mix__softmax_full_mha__ssm_conv_h3__prompt_kernel_do_conv
buffer_load_dwordx4 v[8:11], v1, s[16:19], s98 offen sc1
buffer_load_dwordx4 v[12:15], v1, s[16:19], s98 offen offset:1024 sc1
s_mov_b32 m0, s21
s_nop 0
buffer_load_dwordx4 v1, s[16:19], s20 offen offset:0 sc1 lds
buffer_load_dwordx4 v1, s[16:19], s20 offen offset:1024 sc1 lds
buffer_load_dwordx4 v1, s[16:19], s20 offen offset:2048 sc1 lds
buffer_load_dwordx4 v1, s[16:19], s20 offen offset:3072 sc1 lds
s_add_u32 s99, s99, 1
s_cmp_eq_u32 s99, 8
s_cselect_b32 s7, 0x20000, 0
s_sub_u32 s20, s20, s7
s_and_b32 s99, s99, 7
s_add_u32 s20, s20, 16384
s_add_u32 s21, s21, 32768
s_mov_b32 m0, s21
s_nop 0
buffer_load_dwordx4 v1, s[16:19], s20 offen offset:0 sc1 lds
buffer_load_dwordx4 v1, s[16:19], s20 offen offset:1024 sc1 lds
buffer_load_dwordx4 v1, s[16:19], s20 offen offset:2048 sc1 lds
buffer_load_dwordx4 v1, s[16:19], s20 offen offset:3072 sc1 lds
s_add_u32 s99, s99, 1
s_cmp_eq_u32 s99, 8
s_cselect_b32 s7, 0x20000, 0
s_sub_u32 s20, s20, s7
s_and_b32 s99, s99, 7
s_add_u32 s20, s20, 16384
s_add_u32 s21, s21, 32768
s_mov_b32 s65, 0
v_mov_b32 v160, 0
v_mov_b32 v5, 0
s_branch gated_mix__softmax_full_mha__ssm_conv_h3__prompt_kernel_after_conv
gated_mix__softmax_full_mha__ssm_conv_h3__prompt_kernel_do_conv:
s_lshl_b32 s35, s4, 11
s_add_u32 s35, s35, 131072
v_add_u32 v4, s35, v1
s_xor_b32 s35, s4, 2
s_lshl_b32 s35, s35, 11
s_add_u32 s35, s35, 131072
v_add_u32 v5, s35, v1
s_lshl_b32 s62, s34, 2
s_add_u32 s63, s62, s65
s_sub_u32 s35, 3, s65
s_add_u32 s62, s62, s35
v_lshlrev_b32 v160, 5, v2
v_lshl_add_u32 v160, v3, 3, v160
s_add_u32 s35, s25, 20728
v_sub_u32 v161, s35, v160
s_lshl_b32 s63, s63, 9
s_lshl_b32 s62, s62, 9
v_subrev_u32 v162, s63, v161
v_subrev_u32 v163, s62, v161
ds_read_b64 v[164:165], v162
ds_read_b64 v[166:167], v163
s_bitcmp1_b32 s24, 0
s_cselect_b32 s35, 0, 16
s_lshl_b32 s33, s33, s35
s_and_b32 s33, s33, 0xffff0000
s_add_u32 s27, s27, 8388608
s_add_u32 s30, s63, s27
s_add_u32 s31, s62, s27
ds_read_b64 v[32:33], v6 offset:0
ds_read_b64 v[34:35], v6 offset:8
ds_read_b128 v[64:67], v7 offset:3584
ds_read_b64 v[36:37], v6 offset:512
ds_read_b64 v[38:39], v6 offset:520
ds_read_b128 v[68:71], v7 offset:3072
ds_read_b64 v[40:41], v6 offset:1024
ds_read_b64 v[42:43], v6 offset:1032
ds_read_b128 v[72:75], v7 offset:2560
ds_read_b64 v[44:45], v6 offset:1536
ds_read_b64 v[46:47], v6 offset:1544
ds_read_b128 v[76:79], v7 offset:2048
ds_read_b64 v[48:49], v6 offset:2048
ds_read_b64 v[50:51], v6 offset:2056
ds_read_b128 v[80:83], v7 offset:1536
ds_read_b64 v[52:53], v6 offset:2560
ds_read_b64 v[54:55], v6 offset:2568
ds_read_b128 v[84:87], v7 offset:1024
ds_read_b64 v[56:57], v6 offset:3072
ds_read_b64 v[58:59], v6 offset:3080
ds_read_b128 v[88:91], v7 offset:512
ds_read_b64 v[60:61], v6 offset:3584
ds_read_b64 v[62:63], v6 offset:3592
ds_read_b128 v[92:95], v7 offset:0
v_mov_b32 v16, 0
v_mov_b32 v17, 0
v_mov_b32 v18, 0
v_mov_b32 v19, 0
v_mov_b32 v20, 0
v_mov_b32 v21, 0
v_mov_b32 v22, 0
v_mov_b32 v23, 0
v_mov_b32 v24, 0
v_mov_b32 v25, 0
v_mov_b32 v26, 0
v_mov_b32 v27, 0
v_mov_b32 v28, 0
v_mov_b32 v29, 0
v_mov_b32 v30, 0
v_mov_b32 v31, 0
s_cmp_eq_u32 s65, 1
s_cbranch_scc1 gated_mix__softmax_full_mha__ssm_conv_h3__prompt_kernel_conv_js1
s_waitcnt lgkmcnt(0)
v_mfma_f32_16x16x32_bf16 v[28:31], v[32:35], v[92:95], v[28:31]
ds_read_b64 v[96:97], v6 offset:64
v_mfma_f32_16x16x32_bf16 v[24:27], v[32:35], v[80:83], v[24:27]
ds_read_b64 v[98:99], v6 offset:72
ds_read_b128 v[128:131], v7 offset:3648
buffer_load_dwordx4 v[8:11], v1, s[16:19], s98 offen sc1
buffer_load_dwordx4 v[12:15], v1, s[16:19], s98 offen offset:1024 sc1
v_mfma_f32_16x16x32_bf16 v[20:23], v[32:35], v[76:79], v[20:23]
ds_read_b64 v[100:101], v6 offset:576
ds_read_b64 v[102:103], v6 offset:584
v_mfma_f32_16x16x32_bf16 v[16:19], v[32:35], v[64:67], v[16:19]
ds_read_b128 v[132:135], v7 offset:3136
v_mfma_f32_16x16x32_bf16 v[28:31], v[36:39], v[88:91], v[28:31]
ds_read_b64 v[104:105], v6 offset:1088
ds_read_b64 v[106:107], v6 offset:1096
s_mov_b32 m0, s21
s_nop 0
buffer_load_dwordx4 v1, s[16:19], s20 offen offset:0 sc1 lds
v_mfma_f32_16x16x32_bf16 v[24:27], v[36:39], v[76:79], v[24:27]
ds_read_b128 v[136:139], v7 offset:2624
ds_read_b64 v[108:109], v6 offset:1600
v_mfma_f32_16x16x32_bf16 v[20:23], v[36:39], v[72:75], v[20:23]
ds_read_b64 v[110:111], v6 offset:1608
ds_read_b128 v[140:143], v7 offset:2112
v_mfma_f32_16x16x32_bf16 v[28:31], v[40:43], v[84:87], v[28:31]
ds_read_b64 v[112:113], v6 offset:2112
v_mfma_f32_16x16x32_bf16 v[24:27], v[40:43], v[72:75], v[24:27]
ds_read_b64 v[114:115], v6 offset:2120
ds_read_b128 v[144:147], v7 offset:1600
buffer_load_dwordx4 v1, s[16:19], s20 offen offset:1024 sc1 lds
v_mfma_f32_16x16x32_bf16 v[20:23], v[40:43], v[68:71], v[20:23]
ds_read_b64 v[116:117], v6 offset:2624
ds_read_b64 v[118:119], v6 offset:2632
v_mfma_f32_16x16x32_bf16 v[28:31], v[44:47], v[80:83], v[28:31]
ds_read_b128 v[148:151], v7 offset:1088
v_mfma_f32_16x16x32_bf16 v[24:27], v[44:47], v[68:71], v[24:27]
ds_read_b64 v[120:121], v6 offset:3136
ds_read_b64 v[122:123], v6 offset:3144
v_mfma_f32_16x16x32_bf16 v[20:23], v[44:47], v[64:67], v[20:23]
ds_read_b128 v[152:155], v7 offset:576
ds_read_b64 v[124:125], v6 offset:3648
buffer_load_dwordx4 v1, s[16:19], s20 offen offset:2048 sc1 lds
v_mfma_f32_16x16x32_bf16 v[28:31], v[48:51], v[76:79], v[28:31]
ds_read_b64 v[126:127], v6 offset:3656
ds_read_b128 v[156:159], v7 offset:64
v_mfma_f32_16x16x32_bf16 v[24:27], v[48:51], v[64:67], v[24:27]
v_mfma_f32_16x16x32_bf16 v[28:31], v[52:55], v[72:75], v[28:31]
v_mfma_f32_16x16x32_bf16 v[28:31], v[56:59], v[68:71], v[28:31]
buffer_load_dwordx4 v1, s[16:19], s20 offen offset:3072 sc1 lds
s_add_u32 s99, s99, 1
s_cmp_eq_u32 s99, 8
s_cselect_b32 s7, 0x20000, 0
s_sub_u32 s20, s20, s7
s_and_b32 s99, s99, 7
s_add_u32 s20, s20, 16384
s_add_u32 s21, s21, 32768
v_mfma_f32_16x16x32_bf16 v[28:31], v[60:63], v[64:67], v[28:31]
s_waitcnt lgkmcnt(0)
v_mfma_f32_16x16x32_bf16 v[28:31], v[96:99], v[156:159], v[28:31]
ds_read_b64 v[32:33], v6 offset:128
v_mfma_f32_16x16x32_bf16 v[24:27], v[96:99], v[144:147], v[24:27]
ds_read_b64 v[34:35], v6 offset:136
ds_read_b128 v[64:67], v7 offset:3712
v_mfma_f32_16x16x32_bf16 v[20:23], v[96:99], v[140:143], v[20:23]
ds_read_b64 v[36:37], v6 offset:640
ds_read_b64 v[38:39], v6 offset:648
s_mov_b32 m0, s21
s_nop 0
buffer_load_dwordx4 v1, s[16:19], s20 offen offset:0 sc1 lds
v_mfma_f32_16x16x32_bf16 v[16:19], v[96:99], v[128:131], v[16:19]
ds_read_b128 v[68:71], v7 offset:3200
v_mfma_f32_16x16x32_bf16 v[28:31], v[100:103], v[152:155], v[28:31]
ds_read_b64 v[40:41], v6 offset:1152
ds_read_b64 v[42:43], v6 offset:1160
v_mfma_f32_16x16x32_bf16 v[24:27], v[100:103], v[140:143], v[24:27]
ds_read_b128 v[72:75], v7 offset:2688
ds_read_b64 v[44:45], v6 offset:1664
v_mfma_f32_16x16x32_bf16 v[20:23], v[100:103], v[136:139], v[20:23]
ds_read_b64 v[46:47], v6 offset:1672
ds_read_b128 v[76:79], v7 offset:2176
buffer_load_dwordx4 v1, s[16:19], s20 offen offset:1024 sc1 lds
v_mfma_f32_16x16x32_bf16 v[28:31], v[104:107], v[148:151], v[28:31]
ds_read_b64 v[48:49], v6 offset:2176
v_mfma_f32_16x16x32_bf16 v[24:27], v[104:107], v[136:139], v[24:27]
ds_read_b64 v[50:51], v6 offset:2184
ds_read_b128 v[80:83], v7 offset:1664
v_mfma_f32_16x16x32_bf16 v[20:23], v[104:107], v[132:135], v[20:23]
ds_read_b64 v[52:53], v6 offset:2688
ds_read_b64 v[54:55], v6 offset:2696
v_mfma_f32_16x16x32_bf16 v[28:31], v[108:111], v[144:147], v[28:31]
ds_read_b128 v[84:87], v7 offset:1152
buffer_load_dwordx4 v1, s[16:19], s20 offen offset:2048 sc1 lds
v_mfma_f32_16x16x32_bf16 v[24:27], v[108:111], v[132:135], v[24:27]
ds_read_b64 v[56:57], v6 offset:3200
ds_read_b64 v[58:59], v6 offset:3208
v_mfma_f32_16x16x32_bf16 v[20:23], v[108:111], v[128:131], v[20:23]
ds_read_b128 v[88:91], v7 offset:640
ds_read_b64 v[60:61], v6 offset:3712
v_mfma_f32_16x16x32_bf16 v[28:31], v[112:115], v[140:143], v[28:31]
ds_read_b64 v[62:63], v6 offset:3720
ds_read_b128 v[92:95], v7 offset:128
v_mfma_f32_16x16x32_bf16 v[24:27], v[112:115], v[128:131], v[24:27]
buffer_load_dwordx4 v1, s[16:19], s20 offen offset:3072 sc1 lds
s_add_u32 s99, s99, 1
s_cmp_eq_u32 s99, 8
s_cselect_b32 s7, 0x20000, 0
s_sub_u32 s20, s20, s7
s_and_b32 s99, s99, 7
s_add_u32 s20, s20, 16384
s_add_u32 s21, s21, 32768
v_mfma_f32_16x16x32_bf16 v[28:31], v[116:119], v[136:139], v[28:31]
v_mfma_f32_16x16x32_bf16 v[28:31], v[120:123], v[132:135], v[28:31]
v_mfma_f32_16x16x32_bf16 v[28:31], v[124:127], v[128:131], v[28:31]
v_and_b32 v168, 0xffff0000, v165
v_lshlrev_b32 v169, 16, v165
v_and_b32 v170, 0xffff0000, v164
v_lshlrev_b32 v171, 16, v164
v_and_b32 v172, 0xffff0000, v167
v_lshlrev_b32 v173, 16, v167
v_and_b32 v174, 0xffff0000, v166
v_lshlrev_b32 v175, 16, v166
v_mul_f32 v168, s33, v168
v_mul_f32 v169, s33, v169
v_mul_f32 v170, s33, v170
v_mul_f32 v171, s33, v171
v_mul_f32 v172, s33, v172
v_mul_f32 v173, s33, v173
v_mul_f32 v174, s33, v174
v_mul_f32 v175, s33, v175
s_waitcnt lgkmcnt(0)
v_mfma_f32_16x16x32_bf16 v[28:31], v[32:35], v[92:95], v[28:31]
ds_read_b64 v[96:97], v6 offset:192
v_mfma_f32_16x16x32_bf16 v[24:27], v[32:35], v[80:83], v[24:27]
ds_read_b64 v[98:99], v6 offset:200
ds_read_b128 v[128:131], v7 offset:3776
v_mfma_f32_16x16x32_bf16 v[20:23], v[32:35], v[76:79], v[20:23]
ds_read_b64 v[100:101], v6 offset:704
ds_read_b64 v[102:103], v6 offset:712
v_mfma_f32_16x16x32_bf16 v[16:19], v[32:35], v[64:67], v[16:19]
ds_read_b128 v[132:135], v7 offset:3264
v_mfma_f32_16x16x32_bf16 v[28:31], v[36:39], v[88:91], v[28:31]
ds_read_b64 v[104:105], v6 offset:1216
ds_read_b64 v[106:107], v6 offset:1224
v_mfma_f32_16x16x32_bf16 v[24:27], v[36:39], v[76:79], v[24:27]
ds_read_b128 v[136:139], v7 offset:2752
ds_read_b64 v[108:109], v6 offset:1728
v_mfma_f32_16x16x32_bf16 v[20:23], v[36:39], v[72:75], v[20:23]
ds_read_b64 v[110:111], v6 offset:1736
ds_read_b128 v[140:143], v7 offset:2240
v_mfma_f32_16x16x32_bf16 v[28:31], v[40:43], v[84:87], v[28:31]
ds_read_b64 v[112:113], v6 offset:2240
v_mfma_f32_16x16x32_bf16 v[24:27], v[40:43], v[72:75], v[24:27]
ds_read_b64 v[114:115], v6 offset:2248
ds_read_b128 v[144:147], v7 offset:1728
v_mfma_f32_16x16x32_bf16 v[20:23], v[40:43], v[68:71], v[20:23]
ds_read_b64 v[116:117], v6 offset:2752
ds_read_b64 v[118:119], v6 offset:2760
v_mfma_f32_16x16x32_bf16 v[28:31], v[44:47], v[80:83], v[28:31]
ds_read_b128 v[148:151], v7 offset:1216
v_mfma_f32_16x16x32_bf16 v[24:27], v[44:47], v[68:71], v[24:27]
ds_read_b64 v[120:121], v6 offset:3264
ds_read_b64 v[122:123], v6 offset:3272
v_mfma_f32_16x16x32_bf16 v[20:23], v[44:47], v[64:67], v[20:23]
ds_read_b128 v[152:155], v7 offset:704
ds_read_b64 v[124:125], v6 offset:3776
v_mfma_f32_16x16x32_bf16 v[28:31], v[48:51], v[76:79], v[28:31]
ds_read_b64 v[126:127], v6 offset:3784
ds_read_b128 v[156:159], v7 offset:192
v_mfma_f32_16x16x32_bf16 v[24:27], v[48:51], v[64:67], v[24:27]
v_mfma_f32_16x16x32_bf16 v[28:31], v[52:55], v[72:75], v[28:31]
v_mfma_f32_16x16x32_bf16 v[28:31], v[56:59], v[68:71], v[28:31]
v_mfma_f32_16x16x32_bf16 v[28:31], v[60:63], v[64:67], v[28:31]
s_waitcnt lgkmcnt(0)
v_mfma_f32_16x16x32_bf16 v[28:31], v[96:99], v[156:159], v[28:31]
v_mfma_f32_16x16x32_bf16 v[24:27], v[96:99], v[144:147], v[24:27]
v_mfma_f32_16x16x32_bf16 v[20:23], v[96:99], v[140:143], v[20:23]
v_mfma_f32_16x16x32_bf16 v[16:19], v[96:99], v[128:131], v[16:19]
v_mfma_f32_16x16x32_bf16 v[28:31], v[100:103], v[152:155], v[28:31]
v_mfma_f32_16x16x32_bf16 v[24:27], v[100:103], v[140:143], v[24:27]
v_mfma_f32_16x16x32_bf16 v[20:23], v[100:103], v[136:139], v[20:23]
v_mfma_f32_16x16x32_bf16 v[28:31], v[104:107], v[148:151], v[28:31]
v_mfma_f32_16x16x32_bf16 v[24:27], v[104:107], v[136:139], v[24:27]
v_mfma_f32_16x16x32_bf16 v[20:23], v[104:107], v[132:135], v[20:23]
v_mfma_f32_16x16x32_bf16 v[28:31], v[108:111], v[144:147], v[28:31]
v_mfma_f32_16x16x32_bf16 v[24:27], v[108:111], v[132:135], v[24:27]
v_mfma_f32_16x16x32_bf16 v[20:23], v[108:111], v[128:131], v[20:23]
v_mfma_f32_16x16x32_bf16 v[28:31], v[112:115], v[140:143], v[28:31]
v_mfma_f32_16x16x32_bf16 v[24:27], v[112:115], v[128:131], v[24:27]
v_mfma_f32_16x16x32_bf16 v[28:31], v[116:119], v[136:139], v[28:31]
v_mfma_f32_16x16x32_bf16 v[28:31], v[120:123], v[132:135], v[28:31]
v_mfma_f32_16x16x32_bf16 v[28:31], v[124:127], v[128:131], v[28:31]
s_branch gated_mix__softmax_full_mha__ssm_conv_h3__prompt_kernel_conv_join
gated_mix__softmax_full_mha__ssm_conv_h3__prompt_kernel_conv_js1:
s_waitcnt lgkmcnt(0)
v_mfma_f32_16x16x32_bf16 v[28:31], v[32:35], v[88:91], v[28:31]
ds_read_b64 v[96:97], v6 offset:64
v_mfma_f32_16x16x32_bf16 v[24:27], v[32:35], v[84:87], v[24:27]
ds_read_b64 v[98:99], v6 offset:72
ds_read_b128 v[128:131], v7 offset:3648
buffer_load_dwordx4 v[8:11], v1, s[16:19], s98 offen sc1
buffer_load_dwordx4 v[12:15], v1, s[16:19], s98 offen offset:1024 sc1
v_mfma_f32_16x16x32_bf16 v[20:23], v[32:35], v[72:75], v[20:23]
ds_read_b64 v[100:101], v6 offset:576
ds_read_b64 v[102:103], v6 offset:584
v_mfma_f32_16x16x32_bf16 v[16:19], v[32:35], v[68:71], v[16:19]
ds_read_b128 v[132:135], v7 offset:3136
v_mfma_f32_16x16x32_bf16 v[28:31], v[36:39], v[84:87], v[28:31]
ds_read_b64 v[104:105], v6 offset:1088
ds_read_b64 v[106:107], v6 offset:1096
s_mov_b32 m0, s21
s_nop 0
buffer_load_dwordx4 v1, s[16:19], s20 offen offset:0 sc1 lds
v_mfma_f32_16x16x32_bf16 v[24:27], v[36:39], v[80:83], v[24:27]
ds_read_b128 v[136:139], v7 offset:2624
ds_read_b64 v[108:109], v6 offset:1600
v_mfma_f32_16x16x32_bf16 v[20:23], v[36:39], v[68:71], v[20:23]
ds_read_b64 v[110:111], v6 offset:1608
ds_read_b128 v[140:143], v7 offset:2112
v_mfma_f32_16x16x32_bf16 v[16:19], v[36:39], v[64:67], v[16:19]
ds_read_b64 v[112:113], v6 offset:2112
v_mfma_f32_16x16x32_bf16 v[28:31], v[40:43], v[80:83], v[28:31]
ds_read_b64 v[114:115], v6 offset:2120
ds_read_b128 v[144:147], v7 offset:1600
buffer_load_dwordx4 v1, s[16:19], s20 offen offset:1024 sc1 lds
v_mfma_f32_16x16x32_bf16 v[24:27], v[40:43], v[76:79], v[24:27]
ds_read_b64 v[116:117], v6 offset:2624
ds_read_b64 v[118:119], v6 offset:2632
v_mfma_f32_16x16x32_bf16 v[20:23], v[40:43], v[64:67], v[20:23]
ds_read_b128 v[148:151], v7 offset:1088
v_mfma_f32_16x16x32_bf16 v[28:31], v[44:47], v[76:79], v[28:31]
ds_read_b64 v[120:121], v6 offset:3136
ds_read_b64 v[122:123], v6 offset:3144
v_mfma_f32_16x16x32_bf16 v[24:27], v[44:47], v[72:75], v[24:27]
ds_read_b128 v[152:155], v7 offset:576
ds_read_b64 v[124:125], v6 offset:3648
buffer_load_dwordx4 v1, s[16:19], s20 offen offset:2048 sc1 lds
v_mfma_f32_16x16x32_bf16 v[28:31], v[48:51], v[72:75], v[28:31]
ds_read_b64 v[126:127], v6 offset:3656
ds_read_b128 v[156:159], v7 offset:64
v_mfma_f32_16x16x32_bf16 v[24:27], v[48:51], v[68:71], v[24:27]
v_mfma_f32_16x16x32_bf16 v[28:31], v[52:55], v[68:71], v[28:31]
v_mfma_f32_16x16x32_bf16 v[24:27], v[52:55], v[64:67], v[24:27]
buffer_load_dwordx4 v1, s[16:19], s20 offen offset:3072 sc1 lds
s_add_u32 s99, s99, 1
s_cmp_eq_u32 s99, 8
s_cselect_b32 s7, 0x20000, 0
s_sub_u32 s20, s20, s7
s_and_b32 s99, s99, 7
s_add_u32 s20, s20, 16384
s_add_u32 s21, s21, 32768
v_mfma_f32_16x16x32_bf16 v[28:31], v[56:59], v[64:67], v[28:31]
s_waitcnt lgkmcnt(0)
v_mfma_f32_16x16x32_bf16 v[28:31], v[96:99], v[152:155], v[28:31]
ds_read_b64 v[32:33], v6 offset:128
v_mfma_f32_16x16x32_bf16 v[24:27], v[96:99], v[148:151], v[24:27]
ds_read_b64 v[34:35], v6 offset:136
ds_read_b128 v[64:67], v7 offset:3712
v_mfma_f32_16x16x32_bf16 v[20:23], v[96:99], v[136:139], v[20:23]
ds_read_b64 v[36:37], v6 offset:640
ds_read_b64 v[38:39], v6 offset:648
s_mov_b32 m0, s21
s_nop 0
buffer_load_dwordx4 v1, s[16:19], s20 offen offset:0 sc1 lds
v_mfma_f32_16x16x32_bf16 v[16:19], v[96:99], v[132:135], v[16:19]
ds_read_b128 v[68:71], v7 offset:3200
v_mfma_f32_16x16x32_bf16 v[28:31], v[100:103], v[148:151], v[28:31]
ds_read_b64 v[40:41], v6 offset:1152
ds_read_b64 v[42:43], v6 offset:1160
v_mfma_f32_16x16x32_bf16 v[24:27], v[100:103], v[144:147], v[24:27]
ds_read_b128 v[72:75], v7 offset:2688
ds_read_b64 v[44:45], v6 offset:1664
v_mfma_f32_16x16x32_bf16 v[20:23], v[100:103], v[132:135], v[20:23]
ds_read_b64 v[46:47], v6 offset:1672
ds_read_b128 v[76:79], v7 offset:2176
buffer_load_dwordx4 v1, s[16:19], s20 offen offset:1024 sc1 lds
v_mfma_f32_16x16x32_bf16 v[16:19], v[100:103], v[128:131], v[16:19]
ds_read_b64 v[48:49], v6 offset:2176
v_mfma_f32_16x16x32_bf16 v[28:31], v[104:107], v[144:147], v[28:31]
ds_read_b64 v[50:51], v6 offset:2184
ds_read_b128 v[80:83], v7 offset:1664
v_mfma_f32_16x16x32_bf16 v[24:27], v[104:107], v[140:143], v[24:27]
ds_read_b64 v[52:53], v6 offset:2688
ds_read_b64 v[54:55], v6 offset:2696
v_mfma_f32_16x16x32_bf16 v[20:23], v[104:107], v[128:131], v[20:23]
ds_read_b128 v[84:87], v7 offset:1152
buffer_load_dwordx4 v1, s[16:19], s20 offen offset:2048 sc1 lds
v_mfma_f32_16x16x32_bf16 v[28:31], v[108:111], v[140:143], v[28:31]
ds_read_b64 v[56:57], v6 offset:3200
ds_read_b64 v[58:59], v6 offset:3208
v_mfma_f32_16x16x32_bf16 v[24:27], v[108:111], v[136:139], v[24:27]
ds_read_b128 v[88:91], v7 offset:640
ds_read_b64 v[60:61], v6 offset:3712
v_mfma_f32_16x16x32_bf16 v[28:31], v[112:115], v[136:139], v[28:31]
ds_read_b64 v[62:63], v6 offset:3720
ds_read_b128 v[92:95], v7 offset:128
v_mfma_f32_16x16x32_bf16 v[24:27], v[112:115], v[132:135], v[24:27]
buffer_load_dwordx4 v1, s[16:19], s20 offen offset:3072 sc1 lds
s_add_u32 s99, s99, 1
s_cmp_eq_u32 s99, 8
s_cselect_b32 s7, 0x20000, 0
s_sub_u32 s20, s20, s7
s_and_b32 s99, s99, 7
s_add_u32 s20, s20, 16384
s_add_u32 s21, s21, 32768
v_mfma_f32_16x16x32_bf16 v[28:31], v[116:119], v[132:135], v[28:31]
v_mfma_f32_16x16x32_bf16 v[24:27], v[116:119], v[128:131], v[24:27]
v_mfma_f32_16x16x32_bf16 v[28:31], v[120:123], v[128:131], v[28:31]
v_and_b32 v168, 0xffff0000, v165
v_lshlrev_b32 v169, 16, v165
v_and_b32 v170, 0xffff0000, v164
v_lshlrev_b32 v171, 16, v164
v_and_b32 v172, 0xffff0000, v167
v_lshlrev_b32 v173, 16, v167
v_and_b32 v174, 0xffff0000, v166
v_lshlrev_b32 v175, 16, v166
v_mul_f32 v168, s33, v168
v_mul_f32 v169, s33, v169
v_mul_f32 v170, s33, v170
v_mul_f32 v171, s33, v171
v_mul_f32 v172, s33, v172
v_mul_f32 v173, s33, v173
v_mul_f32 v174, s33, v174
v_mul_f32 v175, s33, v175
s_waitcnt lgkmcnt(0)
v_mfma_f32_16x16x32_bf16 v[28:31], v[32:35], v[88:91], v[28:31]
ds_read_b64 v[96:97], v6 offset:192
v_mfma_f32_16x16x32_bf16 v[24:27], v[32:35], v[84:87], v[24:27]
ds_read_b64 v[98:99], v6 offset:200
ds_read_b128 v[128:131], v7 offset:3776
v_mfma_f32_16x16x32_bf16 v[20:23], v[32:35], v[72:75], v[20:23]
ds_read_b64 v[100:101], v6 offset:704
ds_read_b64 v[102:103], v6 offset:712
v_mfma_f32_16x16x32_bf16 v[16:19], v[32:35], v[68:71], v[16:19]
ds_read_b128 v[132:135], v7 offset:3264
v_mfma_f32_16x16x32_bf16 v[28:31], v[36:39], v[84:87], v[28:31]
ds_read_b64 v[104:105], v6 offset:1216
ds_read_b64 v[106:107], v6 offset:1224
v_mfma_f32_16x16x32_bf16 v[24:27], v[36:39], v[80:83], v[24:27]
ds_read_b128 v[136:139], v7 offset:2752
ds_read_b64 v[108:109], v6 offset:1728
v_mfma_f32_16x16x32_bf16 v[20:23], v[36:39], v[68:71], v[20:23]
ds_read_b64 v[110:111], v6 offset:1736
ds_read_b128 v[140:143], v7 offset:2240
v_mfma_f32_16x16x32_bf16 v[16:19], v[36:39], v[64:67], v[16:19]
ds_read_b64 v[112:113], v6 offset:2240
v_mfma_f32_16x16x32_bf16 v[28:31], v[40:43], v[80:83], v[28:31]
ds_read_b64 v[114:115], v6 offset:2248
ds_read_b128 v[144:147], v7 offset:1728
v_mfma_f32_16x16x32_bf16 v[24:27], v[40:43], v[76:79], v[24:27]
ds_read_b64 v[116:117], v6 offset:2752
ds_read_b64 v[118:119], v6 offset:2760
v_mfma_f32_16x16x32_bf16 v[20:23], v[40:43], v[64:67], v[20:23]
ds_read_b128 v[148:151], v7 offset:1216
v_mfma_f32_16x16x32_bf16 v[28:31], v[44:47], v[76:79], v[28:31]
ds_read_b64 v[120:121], v6 offset:3264
ds_read_b64 v[122:123], v6 offset:3272
v_mfma_f32_16x16x32_bf16 v[24:27], v[44:47], v[72:75], v[24:27]
ds_read_b128 v[152:155], v7 offset:704
ds_read_b64 v[124:125], v6 offset:3776
v_mfma_f32_16x16x32_bf16 v[28:31], v[48:51], v[72:75], v[28:31]
ds_read_b64 v[126:127], v6 offset:3784
ds_read_b128 v[156:159], v7 offset:192
v_mfma_f32_16x16x32_bf16 v[24:27], v[48:51], v[68:71], v[24:27]
v_mfma_f32_16x16x32_bf16 v[28:31], v[52:55], v[68:71], v[28:31]
v_mfma_f32_16x16x32_bf16 v[24:27], v[52:55], v[64:67], v[24:27]
v_mfma_f32_16x16x32_bf16 v[28:31], v[56:59], v[64:67], v[28:31]
s_waitcnt lgkmcnt(0)
v_mfma_f32_16x16x32_bf16 v[28:31], v[96:99], v[152:155], v[28:31]
v_mfma_f32_16x16x32_bf16 v[24:27], v[96:99], v[148:151], v[24:27]
v_mfma_f32_16x16x32_bf16 v[20:23], v[96:99], v[136:139], v[20:23]
v_mfma_f32_16x16x32_bf16 v[16:19], v[96:99], v[132:135], v[16:19]
v_mfma_f32_16x16x32_bf16 v[28:31], v[100:103], v[148:151], v[28:31]
v_mfma_f32_16x16x32_bf16 v[24:27], v[100:103], v[144:147], v[24:27]
v_mfma_f32_16x16x32_bf16 v[20:23], v[100:103], v[132:135], v[20:23]
v_mfma_f32_16x16x32_bf16 v[16:19], v[100:103], v[128:131], v[16:19]
v_mfma_f32_16x16x32_bf16 v[28:31], v[104:107], v[144:147], v[28:31]
v_mfma_f32_16x16x32_bf16 v[24:27], v[104:107], v[140:143], v[24:27]
v_mfma_f32_16x16x32_bf16 v[20:23], v[104:107], v[128:131], v[20:23]
v_mfma_f32_16x16x32_bf16 v[28:31], v[108:111], v[140:143], v[28:31]
v_mfma_f32_16x16x32_bf16 v[24:27], v[108:111], v[136:139], v[24:27]
v_mfma_f32_16x16x32_bf16 v[28:31], v[112:115], v[136:139], v[28:31]
v_mfma_f32_16x16x32_bf16 v[24:27], v[112:115], v[132:135], v[24:27]
v_mfma_f32_16x16x32_bf16 v[28:31], v[116:119], v[132:135], v[28:31]
v_mfma_f32_16x16x32_bf16 v[24:27], v[116:119], v[128:131], v[24:27]
v_mfma_f32_16x16x32_bf16 v[28:31], v[120:123], v[128:131], v[28:31]
gated_mix__softmax_full_mha__ssm_conv_h3__prompt_kernel_conv_join:
s_cmp_eq_u32 s34, 1
s_nop 6
s_cbranch_scc1 gated_mix__softmax_full_mha__ssm_conv_h3__prompt_kernel_conv_rh1
ds_write_b128 v4, v[24:27]
ds_write_b128 v4, v[28:31] offset:1024
v_add_f32 v168, v168, v16
v_add_f32 v169, v169, v17
v_add_f32 v170, v170, v18
v_add_f32 v171, v171, v19
v_add_f32 v172, v172, v20
v_add_f32 v173, v173, v21
v_add_f32 v174, v174, v22
v_add_f32 v175, v175, v23
s_branch gated_mix__softmax_full_mha__ssm_conv_h3__prompt_kernel_conv_rhj
gated_mix__softmax_full_mha__ssm_conv_h3__prompt_kernel_conv_rh1:
ds_write_b128 v4, v[16:19]
ds_write_b128 v4, v[20:23] offset:1024
v_add_f32 v168, v168, v24
v_add_f32 v169, v169, v25
v_add_f32 v170, v170, v26
v_add_f32 v171, v171, v27
v_add_f32 v172, v172, v28
v_add_f32 v173, v173, v29
v_add_f32 v174, v174, v30
v_add_f32 v175, v175, v31
gated_mix__softmax_full_mha__ssm_conv_h3__prompt_kernel_conv_rhj:
s_waitcnt lgkmcnt(0)
s_mov_b32 s65, 1
gated_mix__softmax_full_mha__ssm_conv_h3__prompt_kernel_after_conv:
s_mov_b32 s34, 0
s_waitcnt vmcnt(4)
s_barrier
s_mov_b32 m0, s21
s_nop 0
buffer_load_dwordx4 v1, s[16:19], s20 offen offset:0 sc1 lds
buffer_load_dwordx4 v1, s[16:19], s20 offen offset:1024 sc1 lds
buffer_load_dwordx4 v1, s[16:19], s20 offen offset:2048 sc1 lds
buffer_load_dwordx4 v1, s[16:19], s20 offen offset:3072 sc1 lds
s_add_u32 s99, s99, 1
s_cmp_eq_u32 s99, 8
s_cselect_b32 s7, 0x20000, 0
s_sub_u32 s20, s20, s7
s_and_b32 s99, s99, 7
s_add_u32 s20, s20, 16384
s_add_u32 s21, s21, 32768
gated_mix__softmax_full_mha__ssm_conv_h3__prompt_kernel_attn_go:
s_lshr_b32 s7, s4, 2
s_lshl_b32 s23, s7, 6
s_lshl_b32 s7, s7, 14
v_add_u32 v2, s7, v1
v_add_u32 v3, 65536, v2
s_add_u32 s23, s23, 147712
v_mov_b32 v114, s23
v_mov_b32 v116, 1
s_lshl_b32 s22, s70, 2
s_add_u32 s22, s22, 4
s_cmp_eq_u32 s70, 1
s_cbranch_scc1 gk_11
v_and_b32 v113, 31, v0
v_lshlrev_b32 v113, 2, v113
v_add_u32 v113, 147520, v113
ds_read_b32 v113, v113
gk_11:
ds_read_b128 v[80:83], v2 offset:0
ds_read_b128 v[84:87], v2 offset:1024
ds_read_b128 v[88:91], v2 offset:4096
ds_read_b128 v[92:95], v2 offset:5120
ds_read_b128 v[184:187], v5
ds_read_b128 v[188:191], v5 offset:1024
s_waitcnt lgkmcnt(4)
v_mfma_f32_32x32x16_bf16 v[32:47], v[80:83], v[8:11], 0
v_mfma_f32_32x32x16_bf16 v[32:47], v[84:87], v[12:15], v[32:47]
s_nop 7
s_waitcnt lgkmcnt(0)
ds_read_b128 v[80:83], v2 offset:8192
ds_read_b128 v[84:87], v2 offset:9216
ds_read_b128 v[96:99], v2 offset:2048
ds_read_b128 v[100:103], v2 offset:3072
s_setprio 3
v_mfma_f32_32x32x16_bf16 v[48:63], v[88:91], v[8:11], 0
v_exp_f32 v32, v32
v_exp_f32 v33, v33
v_exp_f32 v34, v34
v_exp_f32 v35, v35
v_cvt_pk_bf16_f32 v64, v32, v33
v_cvt_pk_bf16_f32 v65, v34, v35
v_mfma_f32_32x32x16_bf16 v[48:63], v[92:95], v[12:15], v[48:63]
v_exp_f32 v36, v36
v_exp_f32 v37, v37
v_exp_f32 v38, v38
v_exp_f32 v39, v39
v_cvt_pk_bf16_f32 v66, v36, v37
v_cvt_pk_bf16_f32 v67, v38, v39
v_exp_f32 v40, v40
v_exp_f32 v41, v41
v_exp_f32 v42, v42
v_exp_f32 v43, v43
v_cvt_pk_bf16_f32 v68, v40, v41
v_cvt_pk_bf16_f32 v69, v42, v43
v_exp_f32 v44, v44
v_exp_f32 v45, v45
v_exp_f32 v46, v46
v_exp_f32 v47, v47
v_cvt_pk_bf16_f32 v70, v44, v45
v_cvt_pk_bf16_f32 v71, v46, v47
s_cmp_eq_u32 s65, 0
s_cbranch_scc1 e2_12
v_add_f32 v168, v168, v184
v_add_f32 v169, v169, v185
v_add_f32 v170, v170, v186
v_add_f32 v171, v171, v187
v_add_f32 v172, v172, v188
v_add_f32 v173, v173, v189
v_add_f32 v174, v174, v190
v_add_f32 v175, v175, v191
v_cvt_pk_bf16_f32 v192, v168, v169
v_cvt_pk_bf16_f32 v193, v170, v171
v_cvt_pk_bf16_f32 v194, v172, v173
v_cvt_pk_bf16_f32 v195, v174, v175
buffer_store_dwordx2 v[192:193], v160, s[16:19], s30 offen sc1
buffer_store_dwordx2 v[194:195], v160, s[16:19], s31 offen sc1
s_mov_b32 s65, 0
e2_12:
s_waitcnt lgkmcnt(0)
ds_read_b128 v[88:91], v2 offset:12288
ds_read_b128 v[92:95], v2 offset:13312
ds_read_b128 v[104:107], v2 offset:6144
ds_read_b128 v[108:111], v2 offset:7168
s_waitcnt vmcnt(4)
s_mov_b64 exec, 1
ds_add_u32 v114, v116 offset:4
s_mov_b64 exec, -1
s_setprio 2
v_mfma_f32_32x32x16_bf16 v[32:47], v[80:83], v[8:11], 0
v_exp_f32 v48, v48
v_exp_f32 v49, v49
v_exp_f32 v50, v50
v_exp_f32 v51, v51
v_cvt_pk_bf16_f32 v72, v48, v49
v_cvt_pk_bf16_f32 v73, v50, v51
v_mfma_f32_32x32x16_bf16 v[32:47], v[84:87], v[12:15], v[32:47]
v_exp_f32 v52, v52
v_exp_f32 v53, v53
v_exp_f32 v54, v54
v_exp_f32 v55, v55
v_cvt_pk_bf16_f32 v74, v52, v53
v_cvt_pk_bf16_f32 v75, v54, v55
v_mfma_f32_32x32x16_bf16 v[16:31], v[96:99], v[64:67], 0
v_exp_f32 v56, v56
v_exp_f32 v57, v57
v_exp_f32 v58, v58
v_exp_f32 v59, v59
v_cvt_pk_bf16_f32 v76, v56, v57
v_cvt_pk_bf16_f32 v77, v58, v59
v_mfma_f32_32x32x16_bf16 v[16:31], v[100:103], v[68:71], v[16:31]
v_exp_f32 v60, v60
v_exp_f32 v61, v61
v_exp_f32 v62, v62
v_exp_f32 v63, v63
ds_read_b32 v115, v114 offset:4
v_cvt_pk_bf16_f32 v78, v60, v61
v_cvt_pk_bf16_f32 v79, v62, v63
s_waitcnt lgkmcnt(0)
v_readfirstlane_b32 s7, v115
s_cmp_ge_u32 s7, s22
s_cbranch_scc0 gated_mix__softmax_full_mha__ssm_conv_h3__prompt_kernel_cslow0
gated_mix__softmax_full_mha__ssm_conv_h3__prompt_kernel_cret0:
s_add_u32 m0, s97, 98304
s_nop 0
buffer_load_dwordx4 v1, s[16:19], s20 offen offset:0 sc1 lds
buffer_load_dwordx4 v1, s[16:19], s20 offen offset:1024 sc1 lds
buffer_load_dwordx4 v1, s[16:19], s20 offen offset:2048 sc1 lds
buffer_load_dwordx4 v1, s[16:19], s20 offen offset:3072 sc1 lds
s_add_u32 s99, s99, 1
s_cmp_eq_u32 s99, 8
s_cselect_b32 s7, 0x20000, 0
s_sub_u32 s20, s20, s7
s_and_b32 s99, s99, 7
s_add_u32 s20, s20, 16384
ds_read_b128 v[80:83], v2 offset:32768
ds_read_b128 v[84:87], v2 offset:33792
ds_read_b128 v[96:99], v2 offset:10240
ds_read_b128 v[100:103], v2 offset:11264
s_setprio 1
v_mfma_f32_32x32x16_bf16 v[48:63], v[88:91], v[8:11], 0
v_exp_f32 v32, v32
v_exp_f32 v33, v33
v_exp_f32 v34, v34
v_exp_f32 v35, v35
v_cvt_pk_bf16_f32 v64, v32, v33
v_cvt_pk_bf16_f32 v65, v34, v35
v_mfma_f32_32x32x16_bf16 v[48:63], v[92:95], v[12:15], v[48:63]
v_exp_f32 v36, v36
v_exp_f32 v37, v37
v_exp_f32 v38, v38
v_exp_f32 v39, v39
v_cvt_pk_bf16_f32 v66, v36, v37
v_cvt_pk_bf16_f32 v67, v38, v39
v_mfma_f32_32x32x16_bf16 v[16:31], v[104:107], v[72:75], v[16:31]
v_exp_f32 v40, v40
v_exp_f32 v41, v41
v_exp_f32 v42, v42
v_exp_f32 v43, v43
v_cvt_pk_bf16_f32 v68, v40, v41
v_cvt_pk_bf16_f32 v69, v42, v43
v_mfma_f32_32x32x16_bf16 v[16:31], v[108:111], v[76:79], v[16:31]
v_exp_f32 v44, v44
v_exp_f32 v45, v45
v_exp_f32 v46, v46
v_exp_f32 v47, v47
v_cvt_pk_bf16_f32 v70, v44, v45
v_cvt_pk_bf16_f32 v71, v46, v47
s_waitcnt lgkmcnt(0)
ds_read_b128 v[88:91], v2 offset:36864
ds_read_b128 v[92:95], v2 offset:37888
ds_read_b128 v[104:107], v2 offset:14336
ds_read_b128 v[108:111], v2 offset:15360
s_setprio 0
v_mfma_f32_32x32x16_bf16 v[32:47], v[80:83], v[8:11], 0
v_exp_f32 v48, v48
v_exp_f32 v49, v49
v_exp_f32 v50, v50
v_exp_f32 v51, v51
v_cvt_pk_bf16_f32 v72, v48, v49
v_cvt_pk_bf16_f32 v73, v50, v51
v_mfma_f32_32x32x16_bf16 v[32:47], v[84:87], v[12:15], v[32:47]
v_exp_f32 v52, v52
v_exp_f32 v53, v53
v_exp_f32 v54, v54
v_exp_f32 v55, v55
v_cvt_pk_bf16_f32 v74, v52, v53
v_cvt_pk_bf16_f32 v75, v54, v55
v_mfma_f32_32x32x16_bf16 v[16:31], v[96:99], v[64:67], v[16:31]
v_exp_f32 v56, v56
v_exp_f32 v57, v57
v_exp_f32 v58, v58
v_exp_f32 v59, v59
v_cvt_pk_bf16_f32 v76, v56, v57
v_cvt_pk_bf16_f32 v77, v58, v59
v_mfma_f32_32x32x16_bf16 v[16:31], v[100:103], v[68:71], v[16:31]
v_exp_f32 v60, v60
v_exp_f32 v61, v61
v_exp_f32 v62, v62
v_exp_f32 v63, v63
v_cvt_pk_bf16_f32 v78, v60, v61
v_cvt_pk_bf16_f32 v79, v62, v63
s_waitcnt lgkmcnt(0)
ds_read_b128 v[80:83], v2 offset:40960
ds_read_b128 v[84:87], v2 offset:41984
ds_read_b128 v[96:99], v2 offset:34816
ds_read_b128 v[100:103], v2 offset:35840
s_setprio 3
v_mfma_f32_32x32x16_bf16 v[48:63], v[88:91], v[8:11], 0
v_exp_f32 v32, v32
v_exp_f32 v33, v33
v_exp_f32 v34, v34
v_exp_f32 v35, v35
v_cvt_pk_bf16_f32 v64, v32, v33
v_cvt_pk_bf16_f32 v65, v34, v35
v_mfma_f32_32x32x16_bf16 v[48:63], v[92:95], v[12:15], v[48:63]
v_exp_f32 v36, v36
v_exp_f32 v37, v37
v_exp_f32 v38, v38
v_exp_f32 v39, v39
v_cvt_pk_bf16_f32 v66, v36, v37
v_cvt_pk_bf16_f32 v67, v38, v39
v_mfma_f32_32x32x16_bf16 v[16:31], v[104:107], v[72:75], v[16:31]
v_exp_f32 v40, v40
v_exp_f32 v41, v41
v_exp_f32 v42, v42
v_exp_f32 v43, v43
v_cvt_pk_bf16_f32 v68, v40, v41
v_cvt_pk_bf16_f32 v69, v42, v43
v_mfma_f32_32x32x16_bf16 v[16:31], v[108:111], v[76:79], v[16:31]
v_exp_f32 v44, v44
v_exp_f32 v45, v45
v_exp_f32 v46, v46
v_exp_f32 v47, v47
v_cvt_pk_bf16_f32 v70, v44, v45
v_cvt_pk_bf16_f32 v71, v46, v47
s_waitcnt lgkmcnt(0)
ds_read_b128 v[88:91], v2 offset:45056
ds_read_b128 v[92:95], v2 offset:46080
ds_read_b128 v[104:107], v2 offset:38912
ds_read_b128 v[108:111], v2 offset:39936
s_waitcnt vmcnt(4)
s_mov_b64 exec, 1
ds_add_u32 v114, v116 offset:8
s_mov_b64 exec, -1
s_setprio 2
v_mfma_f32_32x32x16_bf16 v[32:47], v[80:83], v[8:11], 0
v_exp_f32 v48, v48
v_exp_f32 v49, v49
v_exp_f32 v50, v50
v_exp_f32 v51, v51
v_cvt_pk_bf16_f32 v72, v48, v49
v_cvt_pk_bf16_f32 v73, v50, v51
v_mfma_f32_32x32x16_bf16 v[32:47], v[84:87], v[12:15], v[32:47]
v_exp_f32 v52, v52
v_exp_f32 v53, v53
v_exp_f32 v54, v54
v_exp_f32 v55, v55
v_cvt_pk_bf16_f32 v74, v52, v53
v_cvt_pk_bf16_f32 v75, v54, v55
v_mfma_f32_32x32x16_bf16 v[16:31], v[96:99], v[64:67], v[16:31]
v_exp_f32 v56, v56
v_exp_f32 v57, v57
v_exp_f32 v58, v58
v_exp_f32 v59, v59
v_cvt_pk_bf16_f32 v76, v56, v57
v_cvt_pk_bf16_f32 v77, v58, v59
v_mfma_f32_32x32x16_bf16 v[16:31], v[100:103], v[68:71], v[16:31]
v_exp_f32 v60, v60
v_exp_f32 v61, v61
v_exp_f32 v62, v62
v_exp_f32 v63, v63
ds_read_b32 v115, v114 offset:8
v_cvt_pk_bf16_f32 v78, v60, v61
v_cvt_pk_bf16_f32 v79, v62, v63
s_waitcnt lgkmcnt(0)
v_readfirstlane_b32 s7, v115
s_cmp_ge_u32 s7, s22
s_cbranch_scc0 gated_mix__softmax_full_mha__ssm_conv_h3__prompt_kernel_cslow1
gated_mix__softmax_full_mha__ssm_conv_h3__prompt_kernel_cret1:
s_cmp_eq_u32 s71, 0
s_cbranch_scc1 fy_17
v_mov_b32 v250, s64
v_lshlrev_b32 v251, 7, v0
s_mov_b64 s[66:67], exec
s_mov_b64 exec, 1
buffer_store_dword v250, v251, s[16:19], s69 offen sc1
s_mov_b64 exec, s[66:67]
s_mov_b64 exec, -1
s_mov_b32 s71, 0
fy_17:
s_add_u32 m0, s97, 0
s_nop 0
buffer_load_dwordx4 v1, s[16:19], s20 offen offset:0 sc1 lds
buffer_load_dwordx4 v1, s[16:19], s20 offen offset:1024 sc1 lds
buffer_load_dwordx4 v1, s[16:19], s20 offen offset:2048 sc1 lds
buffer_load_dwordx4 v1, s[16:19], s20 offen offset:3072 sc1 lds
s_add_u32 s99, s99, 1
s_cmp_eq_u32 s99, 8
s_cselect_b32 s7, 0x20000, 0
s_sub_u32 s20, s20, s7
s_and_b32 s99, s99, 7
s_add_u32 s20, s20, 16384
ds_read_b128 v[80:83], v3 offset:0
ds_read_b128 v[84:87], v3 offset:1024
ds_read_b128 v[96:99], v2 offset:43008
ds_read_b128 v[100:103], v2 offset:44032
s_setprio 1
v_mfma_f32_32x32x16_bf16 v[48:63], v[88:91], v[8:11], 0
v_exp_f32 v32, v32
v_exp_f32 v33, v33
v_exp_f32 v34, v34
v_exp_f32 v35, v35
v_cvt_pk_bf16_f32 v64, v32, v33
v_cvt_pk_bf16_f32 v65, v34, v35
v_mfma_f32_32x32x16_bf16 v[48:63], v[92:95], v[12:15], v[48:63]
v_exp_f32 v36, v36
v_exp_f32 v37, v37
v_exp_f32 v38, v38
v_exp_f32 v39, v39
v_cvt_pk_bf16_f32 v66, v36, v37
v_cvt_pk_bf16_f32 v67, v38, v39
v_mfma_f32_32x32x16_bf16 v[16:31], v[104:107], v[72:75], v[16:31]
v_exp_f32 v40, v40
v_exp_f32 v41, v41
v_exp_f32 v42, v42
v_exp_f32 v43, v43
v_cvt_pk_bf16_f32 v68, v40, v41
v_cvt_pk_bf16_f32 v69, v42, v43
v_mfma_f32_32x32x16_bf16 v[16:31], v[108:111], v[76:79], v[16:31]
v_exp_f32 v44, v44
v_exp_f32 v45, v45
v_exp_f32 v46, v46
v_exp_f32 v47, v47
v_cvt_pk_bf16_f32 v70, v44, v45
v_cvt_pk_bf16_f32 v71, v46, v47
s_waitcnt lgkmcnt(0)
ds_read_b128 v[88:91], v3 offset:4096
ds_read_b128 v[92:95], v3 offset:5120
ds_read_b128 v[104:107], v2 offset:47104
ds_read_b128 v[108:111], v2 offset:48128
s_setprio 0
v_mfma_f32_32x32x16_bf16 v[32:47], v[80:83], v[8:11], 0
v_exp_f32 v48, v48
v_exp_f32 v49, v49
v_exp_f32 v50, v50
v_exp_f32 v51, v51
v_cvt_pk_bf16_f32 v72, v48, v49
v_cvt_pk_bf16_f32 v73, v50, v51
v_mfma_f32_32x32x16_bf16 v[32:47], v[84:87], v[12:15], v[32:47]
v_exp_f32 v52, v52
v_exp_f32 v53, v53
v_exp_f32 v54, v54
v_exp_f32 v55, v55
v_cvt_pk_bf16_f32 v74, v52, v53
v_cvt_pk_bf16_f32 v75, v54, v55
v_mfma_f32_32x32x16_bf16 v[16:31], v[96:99], v[64:67], v[16:31]
v_exp_f32 v56, v56
v_exp_f32 v57, v57
v_exp_f32 v58, v58
v_exp_f32 v59, v59
v_cvt_pk_bf16_f32 v76, v56, v57
v_cvt_pk_bf16_f32 v77, v58, v59
v_mfma_f32_32x32x16_bf16 v[16:31], v[100:103], v[68:71], v[16:31]
v_exp_f32 v60, v60
v_exp_f32 v61, v61
v_exp_f32 v62, v62
v_exp_f32 v63, v63
v_cvt_pk_bf16_f32 v78, v60, v61
v_cvt_pk_bf16_f32 v79, v62, v63
s_waitcnt lgkmcnt(0)
ds_read_b128 v[80:83], v3 offset:8192
ds_read_b128 v[84:87], v3 offset:9216
ds_read_b128 v[96:99], v3 offset:2048
ds_read_b128 v[100:103], v3 offset:3072
s_setprio 3
v_mfma_f32_32x32x16_bf16 v[48:63], v[88:91], v[8:11], 0
v_exp_f32 v32, v32
v_exp_f32 v33, v33
v_exp_f32 v34, v34
v_exp_f32 v35, v35
v_cvt_pk_bf16_f32 v64, v32, v33
v_cvt_pk_bf16_f32 v65, v34, v35
v_mfma_f32_32x32x16_bf16 v[48:63], v[92:95], v[12:15], v[48:63]
v_exp_f32 v36, v36
v_exp_f32 v37, v37
v_exp_f32 v38, v38
v_exp_f32 v39, v39
v_cvt_pk_bf16_f32 v66, v36, v37
v_cvt_pk_bf16_f32 v67, v38, v39
v_mfma_f32_32x32x16_bf16 v[16:31], v[104:107], v[72:75], v[16:31]
v_exp_f32 v40, v40
v_exp_f32 v41, v41
v_exp_f32 v42, v42
v_exp_f32 v43, v43
v_cvt_pk_bf16_f32 v68, v40, v41
v_cvt_pk_bf16_f32 v69, v42, v43
v_mfma_f32_32x32x16_bf16 v[16:31], v[108:111], v[76:79], v[16:31]
v_exp_f32 v44, v44
v_exp_f32 v45, v45
v_exp_f32 v46, v46
v_exp_f32 v47, v47
v_cvt_pk_bf16_f32 v70, v44, v45
v_cvt_pk_bf16_f32 v71, v46, v47
s_waitcnt lgkmcnt(0)
ds_read_b128 v[88:91], v3 offset:12288
ds_read_b128 v[92:95], v3 offset:13312
ds_read_b128 v[104:107], v3 offset:6144
ds_read_b128 v[108:111], v3 offset:7168
s_waitcnt vmcnt(4)
s_mov_b64 exec, 1
ds_add_u32 v114, v116 offset:12
s_mov_b64 exec, -1
s_setprio 2
v_mfma_f32_32x32x16_bf16 v[32:47], v[80:83], v[8:11], 0
v_exp_f32 v48, v48
v_exp_f32 v49, v49
v_exp_f32 v50, v50
v_exp_f32 v51, v51
v_cvt_pk_bf16_f32 v72, v48, v49
v_cvt_pk_bf16_f32 v73, v50, v51
v_mfma_f32_32x32x16_bf16 v[32:47], v[84:87], v[12:15], v[32:47]
v_exp_f32 v52, v52
v_exp_f32 v53, v53
v_exp_f32 v54, v54
v_exp_f32 v55, v55
v_cvt_pk_bf16_f32 v74, v52, v53
v_cvt_pk_bf16_f32 v75, v54, v55
v_mfma_f32_32x32x16_bf16 v[16:31], v[96:99], v[64:67], v[16:31]
v_exp_f32 v56, v56
v_exp_f32 v57, v57
v_exp_f32 v58, v58
v_exp_f32 v59, v59
v_cvt_pk_bf16_f32 v76, v56, v57
v_cvt_pk_bf16_f32 v77, v58, v59
v_mfma_f32_32x32x16_bf16 v[16:31], v[100:103], v[68:71], v[16:31]
v_exp_f32 v60, v60
v_exp_f32 v61, v61
v_exp_f32 v62, v62
v_exp_f32 v63, v63
ds_read_b32 v115, v114 offset:12
v_cvt_pk_bf16_f32 v78, v60, v61
v_cvt_pk_bf16_f32 v79, v62, v63
s_waitcnt lgkmcnt(0)
v_readfirstlane_b32 s7, v115
s_cmp_ge_u32 s7, s22
s_cbranch_scc0 gated_mix__softmax_full_mha__ssm_conv_h3__prompt_kernel_cslow2
gated_mix__softmax_full_mha__ssm_conv_h3__prompt_kernel_cret2:
s_add_u32 m0, s97, 32768
s_nop 0
buffer_load_dwordx4 v1, s[16:19], s20 offen offset:0 sc1 lds
buffer_load_dwordx4 v1, s[16:19], s20 offen offset:1024 sc1 lds
buffer_load_dwordx4 v1, s[16:19], s20 offen offset:2048 sc1 lds
buffer_load_dwordx4 v1, s[16:19], s20 offen offset:3072 sc1 lds
s_add_u32 s99, s99, 1
s_cmp_eq_u32 s99, 8
s_cselect_b32 s7, 0x20000, 0
s_sub_u32 s20, s20, s7
s_and_b32 s99, s99, 7
s_add_u32 s20, s20, 16384
ds_read_b128 v[80:83], v3 offset:32768
ds_read_b128 v[84:87], v3 offset:33792
ds_read_b128 v[96:99], v3 offset:10240
ds_read_b128 v[100:103], v3 offset:11264
s_setprio 1
v_mfma_f32_32x32x16_bf16 v[48:63], v[88:91], v[8:11], 0
v_exp_f32 v32, v32
v_exp_f32 v33, v33
v_exp_f32 v34, v34
v_exp_f32 v35, v35
v_cvt_pk_bf16_f32 v64, v32, v33
v_cvt_pk_bf16_f32 v65, v34, v35
v_mfma_f32_32x32x16_bf16 v[48:63], v[92:95], v[12:15], v[48:63]
v_exp_f32 v36, v36
v_exp_f32 v37, v37
v_exp_f32 v38, v38
v_exp_f32 v39, v39
v_cvt_pk_bf16_f32 v66, v36, v37
v_cvt_pk_bf16_f32 v67, v38, v39
v_mfma_f32_32x32x16_bf16 v[16:31], v[104:107], v[72:75], v[16:31]
v_exp_f32 v40, v40
v_exp_f32 v41, v41
v_exp_f32 v42, v42
v_exp_f32 v43, v43
v_cvt_pk_bf16_f32 v68, v40, v41
v_cvt_pk_bf16_f32 v69, v42, v43
v_mfma_f32_32x32x16_bf16 v[16:31], v[108:111], v[76:79], v[16:31]
v_exp_f32 v44, v44
v_exp_f32 v45, v45
v_exp_f32 v46, v46
v_exp_f32 v47, v47
v_cvt_pk_bf16_f32 v70, v44, v45
v_cvt_pk_bf16_f32 v71, v46, v47
s_waitcnt lgkmcnt(0)
ds_read_b128 v[88:91], v3 offset:36864
ds_read_b128 v[92:95], v3 offset:37888
ds_read_b128 v[104:107], v3 offset:14336
ds_read_b128 v[108:111], v3 offset:15360
s_setprio 0
v_mfma_f32_32x32x16_bf16 v[32:47], v[80:83], v[8:11], 0
v_exp_f32 v48, v48
v_exp_f32 v49, v49
v_exp_f32 v50, v50
v_exp_f32 v51, v51
v_cvt_pk_bf16_f32 v72, v48, v49
v_cvt_pk_bf16_f32 v73, v50, v51
v_mfma_f32_32x32x16_bf16 v[32:47], v[84:87], v[12:15], v[32:47]
v_exp_f32 v52, v52
v_exp_f32 v53, v53
v_exp_f32 v54, v54
v_exp_f32 v55, v55
v_cvt_pk_bf16_f32 v74, v52, v53
v_cvt_pk_bf16_f32 v75, v54, v55
v_mfma_f32_32x32x16_bf16 v[16:31], v[96:99], v[64:67], v[16:31]
v_exp_f32 v56, v56
v_exp_f32 v57, v57
v_exp_f32 v58, v58
v_exp_f32 v59, v59
v_cvt_pk_bf16_f32 v76, v56, v57
v_cvt_pk_bf16_f32 v77, v58, v59
v_mfma_f32_32x32x16_bf16 v[16:31], v[100:103], v[68:71], v[16:31]
v_exp_f32 v60, v60
v_exp_f32 v61, v61
v_exp_f32 v62, v62
v_exp_f32 v63, v63
v_cvt_pk_bf16_f32 v78, v60, v61
v_cvt_pk_bf16_f32 v79, v62, v63
s_waitcnt lgkmcnt(0)
ds_read_b128 v[80:83], v3 offset:40960
ds_read_b128 v[84:87], v3 offset:41984
ds_read_b128 v[96:99], v3 offset:34816
ds_read_b128 v[100:103], v3 offset:35840
s_setprio 3
v_mfma_f32_32x32x16_bf16 v[48:63], v[88:91], v[8:11], 0
v_exp_f32 v32, v32
v_exp_f32 v33, v33
v_exp_f32 v34, v34
v_exp_f32 v35, v35
v_cvt_pk_bf16_f32 v64, v32, v33
v_cvt_pk_bf16_f32 v65, v34, v35
v_mfma_f32_32x32x16_bf16 v[48:63], v[92:95], v[12:15], v[48:63]
v_exp_f32 v36, v36
v_exp_f32 v37, v37
v_exp_f32 v38, v38
v_exp_f32 v39, v39
v_cvt_pk_bf16_f32 v66, v36, v37
v_cvt_pk_bf16_f32 v67, v38, v39
v_mfma_f32_32x32x16_bf16 v[16:31], v[104:107], v[72:75], v[16:31]
v_exp_f32 v40, v40
v_exp_f32 v41, v41
v_exp_f32 v42, v42
v_exp_f32 v43, v43
v_cvt_pk_bf16_f32 v68, v40, v41
v_cvt_pk_bf16_f32 v69, v42, v43
v_mfma_f32_32x32x16_bf16 v[16:31], v[108:111], v[76:79], v[16:31]
v_exp_f32 v44, v44
v_exp_f32 v45, v45
v_exp_f32 v46, v46
v_exp_f32 v47, v47
v_cvt_pk_bf16_f32 v70, v44, v45
v_cvt_pk_bf16_f32 v71, v46, v47
s_waitcnt lgkmcnt(0)
ds_read_b128 v[88:91], v3 offset:45056
ds_read_b128 v[92:95], v3 offset:46080
ds_read_b128 v[104:107], v3 offset:38912
ds_read_b128 v[108:111], v3 offset:39936
s_waitcnt vmcnt(4)
s_mov_b64 exec, 1
ds_add_u32 v114, v116 offset:16
s_mov_b64 exec, -1
s_setprio 2
v_mfma_f32_32x32x16_bf16 v[32:47], v[80:83], v[8:11], 0
v_exp_f32 v48, v48
v_exp_f32 v49, v49
v_exp_f32 v50, v50
v_exp_f32 v51, v51
v_cvt_pk_bf16_f32 v72, v48, v49
v_cvt_pk_bf16_f32 v73, v50, v51
v_mfma_f32_32x32x16_bf16 v[32:47], v[84:87], v[12:15], v[32:47]
v_exp_f32 v52, v52
v_exp_f32 v53, v53
v_exp_f32 v54, v54
v_exp_f32 v55, v55
v_cvt_pk_bf16_f32 v74, v52, v53
v_cvt_pk_bf16_f32 v75, v54, v55
v_mfma_f32_32x32x16_bf16 v[16:31], v[96:99], v[64:67], v[16:31]
v_exp_f32 v56, v56
v_exp_f32 v57, v57
v_exp_f32 v58, v58
v_exp_f32 v59, v59
v_cvt_pk_bf16_f32 v76, v56, v57
v_cvt_pk_bf16_f32 v77, v58, v59
v_mfma_f32_32x32x16_bf16 v[16:31], v[100:103], v[68:71], v[16:31]
v_exp_f32 v60, v60
v_exp_f32 v61, v61
v_exp_f32 v62, v62
v_exp_f32 v63, v63
ds_read_b32 v115, v114 offset:16
v_cvt_pk_bf16_f32 v78, v60, v61
v_cvt_pk_bf16_f32 v79, v62, v63
s_waitcnt lgkmcnt(0)
v_readfirstlane_b32 s7, v115
s_cmp_ge_u32 s7, s22
s_cbranch_scc0 gated_mix__softmax_full_mha__ssm_conv_h3__prompt_kernel_cslow3
gated_mix__softmax_full_mha__ssm_conv_h3__prompt_kernel_cret3:
s_add_u32 m0, s97, 65536
s_nop 0
buffer_load_dwordx4 v1, s[16:19], s20 offen offset:0 sc1 lds
buffer_load_dwordx4 v1, s[16:19], s20 offen offset:1024 sc1 lds
buffer_load_dwordx4 v1, s[16:19], s20 offen offset:2048 sc1 lds
buffer_load_dwordx4 v1, s[16:19], s20 offen offset:3072 sc1 lds
s_add_u32 s99, s99, 1
s_cmp_eq_u32 s99, 8
s_cselect_b32 s7, 0x20000, 0
s_sub_u32 s20, s20, s7
s_and_b32 s99, s99, 7
s_add_u32 s20, s20, 16384
ds_read_b128 v[80:83], v2 offset:0
ds_read_b128 v[84:87], v2 offset:1024
ds_read_b128 v[96:99], v3 offset:43008
ds_read_b128 v[100:103], v3 offset:44032
s_setprio 1
v_mfma_f32_32x32x16_bf16 v[48:63], v[88:91], v[8:11], 0
v_exp_f32 v32, v32
v_exp_f32 v33, v33
v_exp_f32 v34, v34
v_exp_f32 v35, v35
v_cvt_pk_bf16_f32 v64, v32, v33
v_cvt_pk_bf16_f32 v65, v34, v35
v_mfma_f32_32x32x16_bf16 v[48:63], v[92:95], v[12:15], v[48:63]
v_exp_f32 v36, v36
v_exp_f32 v37, v37
v_exp_f32 v38, v38
v_exp_f32 v39, v39
v_cvt_pk_bf16_f32 v66, v36, v37
v_cvt_pk_bf16_f32 v67, v38, v39
v_mfma_f32_32x32x16_bf16 v[16:31], v[104:107], v[72:75], v[16:31]
v_exp_f32 v40, v40
v_exp_f32 v41, v41
v_exp_f32 v42, v42
v_exp_f32 v43, v43
v_cvt_pk_bf16_f32 v68, v40, v41
v_cvt_pk_bf16_f32 v69, v42, v43
v_mfma_f32_32x32x16_bf16 v[16:31], v[108:111], v[76:79], v[16:31]
v_exp_f32 v44, v44
v_exp_f32 v45, v45
v_exp_f32 v46, v46
v_exp_f32 v47, v47
v_cvt_pk_bf16_f32 v70, v44, v45
v_cvt_pk_bf16_f32 v71, v46, v47
s_waitcnt lgkmcnt(0)
ds_read_b128 v[88:91], v2 offset:4096
ds_read_b128 v[92:95], v2 offset:5120
ds_read_b128 v[104:107], v3 offset:47104
ds_read_b128 v[108:111], v3 offset:48128
s_setprio 0
v_mfma_f32_32x32x16_bf16 v[32:47], v[80:83], v[8:11], 0
v_exp_f32 v48, v48
v_exp_f32 v49, v49
v_exp_f32 v50, v50
v_exp_f32 v51, v51
v_cvt_pk_bf16_f32 v72, v48, v49
v_cvt_pk_bf16_f32 v73, v50, v51
v_mfma_f32_32x32x16_bf16 v[32:47], v[84:87], v[12:15], v[32:47]
v_exp_f32 v52, v52
v_exp_f32 v53, v53
v_exp_f32 v54, v54
v_exp_f32 v55, v55
v_cvt_pk_bf16_f32 v74, v52, v53
v_cvt_pk_bf16_f32 v75, v54, v55
v_mfma_f32_32x32x16_bf16 v[16:31], v[96:99], v[64:67], v[16:31]
v_exp_f32 v56, v56
v_exp_f32 v57, v57
v_exp_f32 v58, v58
v_exp_f32 v59, v59
v_cvt_pk_bf16_f32 v76, v56, v57
v_cvt_pk_bf16_f32 v77, v58, v59
v_mfma_f32_32x32x16_bf16 v[16:31], v[100:103], v[68:71], v[16:31]
v_exp_f32 v60, v60
v_exp_f32 v61, v61
v_exp_f32 v62, v62
v_exp_f32 v63, v63
v_cvt_pk_bf16_f32 v78, v60, v61
v_cvt_pk_bf16_f32 v79, v62, v63
s_waitcnt lgkmcnt(0)
ds_read_b128 v[80:83], v2 offset:8192
ds_read_b128 v[84:87], v2 offset:9216
ds_read_b128 v[96:99], v2 offset:2048
ds_read_b128 v[100:103], v2 offset:3072
s_setprio 3
v_mfma_f32_32x32x16_bf16 v[48:63], v[88:91], v[8:11], 0
v_exp_f32 v32, v32
v_exp_f32 v33, v33
v_exp_f32 v34, v34
v_exp_f32 v35, v35
v_cvt_pk_bf16_f32 v64, v32, v33
v_cvt_pk_bf16_f32 v65, v34, v35
v_mfma_f32_32x32x16_bf16 v[48:63], v[92:95], v[12:15], v[48:63]
v_exp_f32 v36, v36
v_exp_f32 v37, v37
v_exp_f32 v38, v38
v_exp_f32 v39, v39
v_cvt_pk_bf16_f32 v66, v36, v37
v_cvt_pk_bf16_f32 v67, v38, v39
v_mfma_f32_32x32x16_bf16 v[16:31], v[104:107], v[72:75], v[16:31]
v_exp_f32 v40, v40
v_exp_f32 v41, v41
v_exp_f32 v42, v42
v_exp_f32 v43, v43
v_cvt_pk_bf16_f32 v68, v40, v41
v_cvt_pk_bf16_f32 v69, v42, v43
v_mfma_f32_32x32x16_bf16 v[16:31], v[108:111], v[76:79], v[16:31]
v_exp_f32 v44, v44
v_exp_f32 v45, v45
v_exp_f32 v46, v46
v_exp_f32 v47, v47
v_cvt_pk_bf16_f32 v70, v44, v45
v_cvt_pk_bf16_f32 v71, v46, v47
s_waitcnt lgkmcnt(0)
ds_read_b128 v[88:91], v2 offset:12288
ds_read_b128 v[92:95], v2 offset:13312
ds_read_b128 v[104:107], v2 offset:6144
ds_read_b128 v[108:111], v2 offset:7168
s_waitcnt vmcnt(4)
s_mov_b64 exec, 1
ds_add_u32 v114, v116 offset:20
s_mov_b64 exec, -1
s_setprio 2
v_mfma_f32_32x32x16_bf16 v[32:47], v[80:83], v[8:11], 0
v_exp_f32 v48, v48
v_exp_f32 v49, v49
v_exp_f32 v50, v50
v_exp_f32 v51, v51
v_cvt_pk_bf16_f32 v72, v48, v49
v_cvt_pk_bf16_f32 v73, v50, v51
v_mfma_f32_32x32x16_bf16 v[32:47], v[84:87], v[12:15], v[32:47]
v_exp_f32 v52, v52
v_exp_f32 v53, v53
v_exp_f32 v54, v54
v_exp_f32 v55, v55
v_cvt_pk_bf16_f32 v74, v52, v53
v_cvt_pk_bf16_f32 v75, v54, v55
v_mfma_f32_32x32x16_bf16 v[16:31], v[96:99], v[64:67], v[16:31]
v_exp_f32 v56, v56
v_exp_f32 v57, v57
v_exp_f32 v58, v58
v_exp_f32 v59, v59
v_cvt_pk_bf16_f32 v76, v56, v57
v_cvt_pk_bf16_f32 v77, v58, v59
v_mfma_f32_32x32x16_bf16 v[16:31], v[100:103], v[68:71], v[16:31]
v_exp_f32 v60, v60
v_exp_f32 v61, v61
v_exp_f32 v62, v62
v_exp_f32 v63, v63
ds_read_b32 v115, v114 offset:20
v_cvt_pk_bf16_f32 v78, v60, v61
v_cvt_pk_bf16_f32 v79, v62, v63
s_waitcnt lgkmcnt(0)
v_readfirstlane_b32 s7, v115
s_cmp_ge_u32 s7, s22
s_cbranch_scc0 gated_mix__softmax_full_mha__ssm_conv_h3__prompt_kernel_cslow4
gated_mix__softmax_full_mha__ssm_conv_h3__prompt_kernel_cret4:
s_add_u32 m0, s97, 98304
s_nop 0
buffer_load_dwordx4 v1, s[16:19], s20 offen offset:0 sc1 lds
buffer_load_dwordx4 v1, s[16:19], s20 offen offset:1024 sc1 lds
buffer_load_dwordx4 v1, s[16:19], s20 offen offset:2048 sc1 lds
buffer_load_dwordx4 v1, s[16:19], s20 offen offset:3072 sc1 lds
ds_read_b128 v[80:83], v2 offset:32768
ds_read_b128 v[84:87], v2 offset:33792
ds_read_b128 v[96:99], v2 offset:10240
ds_read_b128 v[100:103], v2 offset:11264
s_setprio 1
v_mfma_f32_32x32x16_bf16 v[48:63], v[88:91], v[8:11], 0
v_exp_f32 v32, v32
v_exp_f32 v33, v33
v_exp_f32 v34, v34
v_exp_f32 v35, v35
v_cvt_pk_bf16_f32 v64, v32, v33
v_cvt_pk_bf16_f32 v65, v34, v35
v_mfma_f32_32x32x16_bf16 v[48:63], v[92:95], v[12:15], v[48:63]
v_exp_f32 v36, v36
v_exp_f32 v37, v37
v_exp_f32 v38, v38
v_exp_f32 v39, v39
v_cvt_pk_bf16_f32 v66, v36, v37
v_cvt_pk_bf16_f32 v67, v38, v39
v_mfma_f32_32x32x16_bf16 v[16:31], v[104:107], v[72:75], v[16:31]
v_exp_f32 v40, v40
v_exp_f32 v41, v41
v_exp_f32 v42, v42
v_exp_f32 v43, v43
v_cvt_pk_bf16_f32 v68, v40, v41
v_cvt_pk_bf16_f32 v69, v42, v43
v_mfma_f32_32x32x16_bf16 v[16:31], v[108:111], v[76:79], v[16:31]
v_exp_f32 v44, v44
v_exp_f32 v45, v45
v_exp_f32 v46, v46
v_exp_f32 v47, v47
v_cvt_pk_bf16_f32 v70, v44, v45
v_cvt_pk_bf16_f32 v71, v46, v47
s_waitcnt lgkmcnt(0)
ds_read_b128 v[88:91], v2 offset:36864
ds_read_b128 v[92:95], v2 offset:37888
ds_read_b128 v[104:107], v2 offset:14336
ds_read_b128 v[108:111], v2 offset:15360
s_setprio 0
v_mfma_f32_32x32x16_bf16 v[32:47], v[80:83], v[8:11], 0
v_exp_f32 v48, v48
v_exp_f32 v49, v49
v_exp_f32 v50, v50
v_exp_f32 v51, v51
v_cvt_pk_bf16_f32 v72, v48, v49
v_cvt_pk_bf16_f32 v73, v50, v51
v_mfma_f32_32x32x16_bf16 v[32:47], v[84:87], v[12:15], v[32:47]
v_exp_f32 v52, v52
v_exp_f32 v53, v53
v_exp_f32 v54, v54
v_exp_f32 v55, v55
v_cvt_pk_bf16_f32 v74, v52, v53
v_cvt_pk_bf16_f32 v75, v54, v55
v_mfma_f32_32x32x16_bf16 v[16:31], v[96:99], v[64:67], v[16:31]
v_exp_f32 v56, v56
v_exp_f32 v57, v57
v_exp_f32 v58, v58
v_exp_f32 v59, v59
v_cvt_pk_bf16_f32 v76, v56, v57
v_cvt_pk_bf16_f32 v77, v58, v59
v_mfma_f32_32x32x16_bf16 v[16:31], v[100:103], v[68:71], v[16:31]
v_exp_f32 v60, v60
v_exp_f32 v61, v61
v_exp_f32 v62, v62
v_exp_f32 v63, v63
v_cvt_pk_bf16_f32 v78, v60, v61
v_cvt_pk_bf16_f32 v79, v62, v63
s_waitcnt lgkmcnt(0)
ds_read_b128 v[80:83], v2 offset:40960
ds_read_b128 v[84:87], v2 offset:41984
ds_read_b128 v[96:99], v2 offset:34816
ds_read_b128 v[100:103], v2 offset:35840
s_setprio 3
v_mfma_f32_32x32x16_bf16 v[48:63], v[88:91], v[8:11], 0
v_exp_f32 v32, v32
v_exp_f32 v33, v33
v_exp_f32 v34, v34
v_exp_f32 v35, v35
v_cvt_pk_bf16_f32 v64, v32, v33
v_cvt_pk_bf16_f32 v65, v34, v35
v_mfma_f32_32x32x16_bf16 v[48:63], v[92:95], v[12:15], v[48:63]
v_exp_f32 v36, v36
v_exp_f32 v37, v37
v_exp_f32 v38, v38
v_exp_f32 v39, v39
v_cvt_pk_bf16_f32 v66, v36, v37
v_cvt_pk_bf16_f32 v67, v38, v39
v_mfma_f32_32x32x16_bf16 v[16:31], v[104:107], v[72:75], v[16:31]
v_exp_f32 v40, v40
v_exp_f32 v41, v41
v_exp_f32 v42, v42
v_exp_f32 v43, v43
v_cvt_pk_bf16_f32 v68, v40, v41
v_cvt_pk_bf16_f32 v69, v42, v43
v_mfma_f32_32x32x16_bf16 v[16:31], v[108:111], v[76:79], v[16:31]
v_exp_f32 v44, v44
v_exp_f32 v45, v45
v_exp_f32 v46, v46
v_exp_f32 v47, v47
v_cvt_pk_bf16_f32 v70, v44, v45
v_cvt_pk_bf16_f32 v71, v46, v47
s_waitcnt lgkmcnt(0)
ds_read_b128 v[88:91], v2 offset:45056
ds_read_b128 v[92:95], v2 offset:46080
ds_read_b128 v[104:107], v2 offset:38912
ds_read_b128 v[108:111], v2 offset:39936
s_waitcnt vmcnt(4)
s_mov_b64 exec, 1
ds_add_u32 v114, v116 offset:24
s_mov_b64 exec, -1
s_setprio 2
v_mfma_f32_32x32x16_bf16 v[32:47], v[80:83], v[8:11], 0
v_exp_f32 v48, v48
v_exp_f32 v49, v49
v_exp_f32 v50, v50
v_exp_f32 v51, v51
v_cvt_pk_bf16_f32 v72, v48, v49
v_cvt_pk_bf16_f32 v73, v50, v51
v_mfma_f32_32x32x16_bf16 v[32:47], v[84:87], v[12:15], v[32:47]
v_exp_f32 v52, v52
v_exp_f32 v53, v53
v_exp_f32 v54, v54
v_exp_f32 v55, v55
v_cvt_pk_bf16_f32 v74, v52, v53
v_cvt_pk_bf16_f32 v75, v54, v55
v_mfma_f32_32x32x16_bf16 v[16:31], v[96:99], v[64:67], v[16:31]
v_exp_f32 v56, v56
v_exp_f32 v57, v57
v_exp_f32 v58, v58
v_exp_f32 v59, v59
v_cvt_pk_bf16_f32 v76, v56, v57
v_cvt_pk_bf16_f32 v77, v58, v59
v_mfma_f32_32x32x16_bf16 v[16:31], v[100:103], v[68:71], v[16:31]
v_exp_f32 v60, v60
v_exp_f32 v61, v61
v_exp_f32 v62, v62
v_exp_f32 v63, v63
ds_read_b32 v115, v114 offset:24
v_cvt_pk_bf16_f32 v78, v60, v61
v_cvt_pk_bf16_f32 v79, v62, v63
s_waitcnt lgkmcnt(0)
v_readfirstlane_b32 s7, v115
s_cmp_ge_u32 s7, s22
s_cbranch_scc0 gated_mix__softmax_full_mha__ssm_conv_h3__prompt_kernel_cslow5
gated_mix__softmax_full_mha__ssm_conv_h3__prompt_kernel_cret5:
s_lshl_b32 s24, s4, 2
s_mul_i32 s27, s24, 3584
s_add_u32 s27, s27, s96
s_lshl_b32 m0, s24, 10
s_nop 0
buffer_load_dwordx4 v180, s[8:11], s27 offen lds
s_add_u32 s27, s27, 3584
s_add_u32 m0, m0, 1024
s_nop 0
buffer_load_dwordx4 v180, s[8:11], s27 offen lds
s_add_u32 s27, s27, 3584
s_add_u32 m0, m0, 1024
s_nop 0
buffer_load_dwordx4 v180, s[8:11], s27 offen lds
s_add_u32 s27, s27, 3584
s_add_u32 m0, m0, 1024
s_nop 0
buffer_load_dwordx4 v180, s[8:11], s27 offen lds
ds_read_b128 v[80:83], v3 offset:0
ds_read_b128 v[84:87], v3 offset:1024
ds_read_b128 v[96:99], v2 offset:43008
ds_read_b128 v[100:103], v2 offset:44032
s_setprio 1
v_mfma_f32_32x32x16_bf16 v[48:63], v[88:91], v[8:11], 0
v_exp_f32 v32, v32
v_exp_f32 v33, v33
v_exp_f32 v34, v34
v_exp_f32 v35, v35
v_cvt_pk_bf16_f32 v64, v32, v33
v_cvt_pk_bf16_f32 v65, v34, v35
v_mfma_f32_32x32x16_bf16 v[48:63], v[92:95], v[12:15], v[48:63]
v_exp_f32 v36, v36
v_exp_f32 v37, v37
v_exp_f32 v38, v38
v_exp_f32 v39, v39
v_cvt_pk_bf16_f32 v66, v36, v37
v_cvt_pk_bf16_f32 v67, v38, v39
v_mfma_f32_32x32x16_bf16 v[16:31], v[104:107], v[72:75], v[16:31]
v_exp_f32 v40, v40
v_exp_f32 v41, v41
v_exp_f32 v42, v42
v_exp_f32 v43, v43
v_cvt_pk_bf16_f32 v68, v40, v41
v_cvt_pk_bf16_f32 v69, v42, v43
v_mfma_f32_32x32x16_bf16 v[16:31], v[108:111], v[76:79], v[16:31]
v_exp_f32 v44, v44
v_exp_f32 v45, v45
v_exp_f32 v46, v46
v_exp_f32 v47, v47
v_cvt_pk_bf16_f32 v70, v44, v45
v_cvt_pk_bf16_f32 v71, v46, v47
s_waitcnt lgkmcnt(0)
ds_read_b128 v[88:91], v3 offset:4096
ds_read_b128 v[92:95], v3 offset:5120
ds_read_b128 v[104:107], v2 offset:47104
ds_read_b128 v[108:111], v2 offset:48128
s_setprio 0
v_mfma_f32_32x32x16_bf16 v[32:47], v[80:83], v[8:11], 0
v_exp_f32 v48, v48
v_exp_f32 v49, v49
v_exp_f32 v50, v50
v_exp_f32 v51, v51
v_cvt_pk_bf16_f32 v72, v48, v49
v_cvt_pk_bf16_f32 v73, v50, v51
v_mfma_f32_32x32x16_bf16 v[32:47], v[84:87], v[12:15], v[32:47]
v_exp_f32 v52, v52
v_exp_f32 v53, v53
v_exp_f32 v54, v54
v_exp_f32 v55, v55
v_cvt_pk_bf16_f32 v74, v52, v53
v_cvt_pk_bf16_f32 v75, v54, v55
v_mfma_f32_32x32x16_bf16 v[16:31], v[96:99], v[64:67], v[16:31]
v_exp_f32 v56, v56
v_exp_f32 v57, v57
v_exp_f32 v58, v58
v_exp_f32 v59, v59
v_cvt_pk_bf16_f32 v76, v56, v57
v_cvt_pk_bf16_f32 v77, v58, v59
v_mfma_f32_32x32x16_bf16 v[16:31], v[100:103], v[68:71], v[16:31]
v_exp_f32 v60, v60
v_exp_f32 v61, v61
v_exp_f32 v62, v62
v_exp_f32 v63, v63
v_cvt_pk_bf16_f32 v78, v60, v61
v_cvt_pk_bf16_f32 v79, v62, v63
s_waitcnt lgkmcnt(0)
ds_read_b128 v[80:83], v3 offset:8192
ds_read_b128 v[84:87], v3 offset:9216
ds_read_b128 v[96:99], v3 offset:2048
ds_read_b128 v[100:103], v3 offset:3072
s_setprio 3
v_mfma_f32_32x32x16_bf16 v[48:63], v[88:91], v[8:11], 0
v_exp_f32 v32, v32
v_exp_f32 v33, v33
v_exp_f32 v34, v34
v_exp_f32 v35, v35
v_cvt_pk_bf16_f32 v64, v32, v33
v_cvt_pk_bf16_f32 v65, v34, v35
v_mfma_f32_32x32x16_bf16 v[48:63], v[92:95], v[12:15], v[48:63]
v_exp_f32 v36, v36
v_exp_f32 v37, v37
v_exp_f32 v38, v38
v_exp_f32 v39, v39
v_cvt_pk_bf16_f32 v66, v36, v37
v_cvt_pk_bf16_f32 v67, v38, v39
v_mfma_f32_32x32x16_bf16 v[16:31], v[104:107], v[72:75], v[16:31]
v_exp_f32 v40, v40
v_exp_f32 v41, v41
v_exp_f32 v42, v42
v_exp_f32 v43, v43
v_cvt_pk_bf16_f32 v68, v40, v41
v_cvt_pk_bf16_f32 v69, v42, v43
v_mfma_f32_32x32x16_bf16 v[16:31], v[108:111], v[76:79], v[16:31]
v_exp_f32 v44, v44
v_exp_f32 v45, v45
v_exp_f32 v46, v46
v_exp_f32 v47, v47
v_cvt_pk_bf16_f32 v70, v44, v45
v_cvt_pk_bf16_f32 v71, v46, v47
s_waitcnt lgkmcnt(0)
ds_read_b128 v[88:91], v3 offset:12288
ds_read_b128 v[92:95], v3 offset:13312
ds_read_b128 v[104:107], v3 offset:6144
ds_read_b128 v[108:111], v3 offset:7168
s_waitcnt vmcnt(4)
s_mov_b64 exec, 1
ds_add_u32 v114, v116 offset:28
s_mov_b64 exec, -1
s_setprio 2
v_mfma_f32_32x32x16_bf16 v[32:47], v[80:83], v[8:11], 0
v_exp_f32 v48, v48
v_exp_f32 v49, v49
v_exp_f32 v50, v50
v_exp_f32 v51, v51
v_cvt_pk_bf16_f32 v72, v48, v49
v_cvt_pk_bf16_f32 v73, v50, v51
v_mfma_f32_32x32x16_bf16 v[32:47], v[84:87], v[12:15], v[32:47]
v_exp_f32 v52, v52
v_exp_f32 v53, v53
v_exp_f32 v54, v54
v_exp_f32 v55, v55
v_cvt_pk_bf16_f32 v74, v52, v53
v_cvt_pk_bf16_f32 v75, v54, v55
v_mfma_f32_32x32x16_bf16 v[16:31], v[96:99], v[64:67], v[16:31]
v_exp_f32 v56, v56
v_exp_f32 v57, v57
v_exp_f32 v58, v58
v_exp_f32 v59, v59
v_cvt_pk_bf16_f32 v76, v56, v57
v_cvt_pk_bf16_f32 v77, v58, v59
v_mfma_f32_32x32x16_bf16 v[16:31], v[100:103], v[68:71], v[16:31]
v_exp_f32 v60, v60
v_exp_f32 v61, v61
v_exp_f32 v62, v62
v_exp_f32 v63, v63
ds_read_b32 v115, v114 offset:28
v_cvt_pk_bf16_f32 v78, v60, v61
v_cvt_pk_bf16_f32 v79, v62, v63
s_waitcnt lgkmcnt(0)
v_readfirstlane_b32 s7, v115
s_cmp_ge_u32 s7, s22
s_cbranch_scc0 gated_mix__softmax_full_mha__ssm_conv_h3__prompt_kernel_cslow6
gated_mix__softmax_full_mha__ssm_conv_h3__prompt_kernel_cret6:
s_lshl_b32 s24, s4, 2
s_add_u32 s24, s24, 32
s_mul_i32 s27, s24, 3584
s_add_u32 s27, s27, s96
s_lshl_b32 m0, s24, 10
s_nop 0
buffer_load_dwordx4 v180, s[8:11], s27 offen lds
s_add_u32 s27, s27, 3584
s_add_u32 m0, m0, 1024
s_nop 0
buffer_load_dwordx4 v180, s[8:11], s27 offen lds
s_add_u32 s27, s27, 3584
s_add_u32 m0, m0, 1024
s_nop 0
buffer_load_dwordx4 v180, s[8:11], s27 offen lds
s_add_u32 s27, s27, 3584
s_add_u32 m0, m0, 1024
s_nop 0
buffer_load_dwordx4 v180, s[8:11], s27 offen lds
ds_read_b128 v[80:83], v3 offset:32768
ds_read_b128 v[84:87], v3 offset:33792
ds_read_b128 v[96:99], v3 offset:10240
ds_read_b128 v[100:103], v3 offset:11264
s_setprio 1
v_mfma_f32_32x32x16_bf16 v[48:63], v[88:91], v[8:11], 0
v_exp_f32 v32, v32
v_exp_f32 v33, v33
v_exp_f32 v34, v34
v_exp_f32 v35, v35
v_cvt_pk_bf16_f32 v64, v32, v33
v_cvt_pk_bf16_f32 v65, v34, v35
v_mfma_f32_32x32x16_bf16 v[48:63], v[92:95], v[12:15], v[48:63]
v_exp_f32 v36, v36
v_exp_f32 v37, v37
v_exp_f32 v38, v38
v_exp_f32 v39, v39
v_cvt_pk_bf16_f32 v66, v36, v37
v_cvt_pk_bf16_f32 v67, v38, v39
v_mfma_f32_32x32x16_bf16 v[16:31], v[104:107], v[72:75], v[16:31]
v_exp_f32 v40, v40
v_exp_f32 v41, v41
v_exp_f32 v42, v42
v_exp_f32 v43, v43
v_cvt_pk_bf16_f32 v68, v40, v41
v_cvt_pk_bf16_f32 v69, v42, v43
v_mfma_f32_32x32x16_bf16 v[16:31], v[108:111], v[76:79], v[16:31]
v_exp_f32 v44, v44
v_exp_f32 v45, v45
v_exp_f32 v46, v46
v_exp_f32 v47, v47
v_cvt_pk_bf16_f32 v70, v44, v45
v_cvt_pk_bf16_f32 v71, v46, v47
s_waitcnt lgkmcnt(0)
ds_read_b128 v[88:91], v3 offset:36864
ds_read_b128 v[92:95], v3 offset:37888
ds_read_b128 v[104:107], v3 offset:14336
ds_read_b128 v[108:111], v3 offset:15360
s_setprio 0
v_mfma_f32_32x32x16_bf16 v[32:47], v[80:83], v[8:11], 0
v_exp_f32 v48, v48
v_exp_f32 v49, v49
v_exp_f32 v50, v50
v_exp_f32 v51, v51
v_cvt_pk_bf16_f32 v72, v48, v49
v_cvt_pk_bf16_f32 v73, v50, v51
v_mfma_f32_32x32x16_bf16 v[32:47], v[84:87], v[12:15], v[32:47]
v_exp_f32 v52, v52
v_exp_f32 v53, v53
v_exp_f32 v54, v54
v_exp_f32 v55, v55
v_cvt_pk_bf16_f32 v74, v52, v53
v_cvt_pk_bf16_f32 v75, v54, v55
v_mfma_f32_32x32x16_bf16 v[16:31], v[96:99], v[64:67], v[16:31]
v_exp_f32 v56, v56
v_exp_f32 v57, v57
v_exp_f32 v58, v58
v_exp_f32 v59, v59
v_cvt_pk_bf16_f32 v76, v56, v57
v_cvt_pk_bf16_f32 v77, v58, v59
v_mfma_f32_32x32x16_bf16 v[16:31], v[100:103], v[68:71], v[16:31]
v_exp_f32 v60, v60
v_exp_f32 v61, v61
v_exp_f32 v62, v62
v_exp_f32 v63, v63
v_cvt_pk_bf16_f32 v78, v60, v61
v_cvt_pk_bf16_f32 v79, v62, v63
s_waitcnt lgkmcnt(0)
ds_read_b128 v[80:83], v3 offset:40960
ds_read_b128 v[84:87], v3 offset:41984
ds_read_b128 v[96:99], v3 offset:34816
ds_read_b128 v[100:103], v3 offset:35840
s_setprio 3
v_mfma_f32_32x32x16_bf16 v[48:63], v[88:91], v[8:11], 0
v_exp_f32 v32, v32
v_exp_f32 v33, v33
v_exp_f32 v34, v34
v_exp_f32 v35, v35
v_cvt_pk_bf16_f32 v64, v32, v33
v_cvt_pk_bf16_f32 v65, v34, v35
v_mfma_f32_32x32x16_bf16 v[48:63], v[92:95], v[12:15], v[48:63]
v_exp_f32 v36, v36
v_exp_f32 v37, v37
v_exp_f32 v38, v38
v_exp_f32 v39, v39
v_cvt_pk_bf16_f32 v66, v36, v37
v_cvt_pk_bf16_f32 v67, v38, v39
v_mfma_f32_32x32x16_bf16 v[16:31], v[104:107], v[72:75], v[16:31]
v_exp_f32 v40, v40
v_exp_f32 v41, v41
v_exp_f32 v42, v42
v_exp_f32 v43, v43
v_cvt_pk_bf16_f32 v68, v40, v41
v_cvt_pk_bf16_f32 v69, v42, v43
v_mfma_f32_32x32x16_bf16 v[16:31], v[108:111], v[76:79], v[16:31]
v_exp_f32 v44, v44
v_exp_f32 v45, v45
v_exp_f32 v46, v46
v_exp_f32 v47, v47
v_cvt_pk_bf16_f32 v70, v44, v45
v_cvt_pk_bf16_f32 v71, v46, v47
s_waitcnt lgkmcnt(0)
ds_read_b128 v[88:91], v3 offset:45056
ds_read_b128 v[92:95], v3 offset:46080
ds_read_b128 v[104:107], v3 offset:38912
ds_read_b128 v[108:111], v3 offset:39936
s_waitcnt vmcnt(4)
s_mov_b64 exec, 1
ds_add_u32 v114, v116 offset:32
s_mov_b64 exec, -1
s_setprio 2
v_mfma_f32_32x32x16_bf16 v[32:47], v[80:83], v[8:11], 0
v_exp_f32 v48, v48
v_exp_f32 v49, v49
v_exp_f32 v50, v50
v_exp_f32 v51, v51
v_cvt_pk_bf16_f32 v72, v48, v49
v_cvt_pk_bf16_f32 v73, v50, v51
v_mfma_f32_32x32x16_bf16 v[32:47], v[84:87], v[12:15], v[32:47]
v_exp_f32 v52, v52
v_exp_f32 v53, v53
v_exp_f32 v54, v54
v_exp_f32 v55, v55
v_cvt_pk_bf16_f32 v74, v52, v53
v_cvt_pk_bf16_f32 v75, v54, v55
v_mfma_f32_32x32x16_bf16 v[16:31], v[96:99], v[64:67], v[16:31]
v_exp_f32 v56, v56
v_exp_f32 v57, v57
v_exp_f32 v58, v58
v_exp_f32 v59, v59
v_cvt_pk_bf16_f32 v76, v56, v57
v_cvt_pk_bf16_f32 v77, v58, v59
v_mfma_f32_32x32x16_bf16 v[16:31], v[100:103], v[68:71], v[16:31]
v_exp_f32 v60, v60
v_exp_f32 v61, v61
v_exp_f32 v62, v62
v_exp_f32 v63, v63
ds_read_b32 v115, v114 offset:32
v_cvt_pk_bf16_f32 v78, v60, v61
v_cvt_pk_bf16_f32 v79, v62, v63
s_waitcnt lgkmcnt(0)
v_readfirstlane_b32 s7, v115
s_cmp_ge_u32 s7, s22
s_cbranch_scc0 gated_mix__softmax_full_mha__ssm_conv_h3__prompt_kernel_cslow7
gated_mix__softmax_full_mha__ssm_conv_h3__prompt_kernel_cret7:
s_lshl_b32 s24, s4, 2
s_add_u32 s24, s24, 64
s_mul_i32 s27, s24, 3584
s_add_u32 s27, s27, s96
s_lshl_b32 m0, s24, 10
s_nop 0
buffer_load_dwordx4 v180, s[8:11], s27 offen lds
s_add_u32 s27, s27, 3584
s_add_u32 m0, m0, 1024
s_nop 0
buffer_load_dwordx4 v180, s[8:11], s27 offen lds
s_add_u32 s27, s27, 3584
s_add_u32 m0, m0, 1024
s_nop 0
buffer_load_dwordx4 v180, s[8:11], s27 offen lds
s_add_u32 s27, s27, 3584
s_add_u32 m0, m0, 1024
s_nop 0
buffer_load_dwordx4 v180, s[8:11], s27 offen lds
ds_read_b128 v[96:99], v3 offset:43008
ds_read_b128 v[100:103], v3 offset:44032
s_setprio 1
v_mfma_f32_32x32x16_bf16 v[48:63], v[88:91], v[8:11], 0
v_exp_f32 v32, v32
v_exp_f32 v33, v33
v_exp_f32 v34, v34
v_exp_f32 v35, v35
v_cvt_pk_bf16_f32 v64, v32, v33
v_cvt_pk_bf16_f32 v65, v34, v35
v_mfma_f32_32x32x16_bf16 v[48:63], v[92:95], v[12:15], v[48:63]
v_exp_f32 v36, v36
v_exp_f32 v37, v37
v_exp_f32 v38, v38
v_exp_f32 v39, v39
v_cvt_pk_bf16_f32 v66, v36, v37
v_cvt_pk_bf16_f32 v67, v38, v39
v_mfma_f32_32x32x16_bf16 v[16:31], v[104:107], v[72:75], v[16:31]
v_exp_f32 v40, v40
v_exp_f32 v41, v41
v_exp_f32 v42, v42
v_exp_f32 v43, v43
v_cvt_pk_bf16_f32 v68, v40, v41
v_cvt_pk_bf16_f32 v69, v42, v43
v_mfma_f32_32x32x16_bf16 v[16:31], v[108:111], v[76:79], v[16:31]
v_exp_f32 v44, v44
v_exp_f32 v45, v45
v_exp_f32 v46, v46
v_exp_f32 v47, v47
v_cvt_pk_bf16_f32 v70, v44, v45
v_cvt_pk_bf16_f32 v71, v46, v47
s_waitcnt lgkmcnt(0)
ds_read_b128 v[104:107], v3 offset:47104
ds_read_b128 v[108:111], v3 offset:48128
s_setprio 0
v_exp_f32 v48, v48
v_exp_f32 v49, v49
v_exp_f32 v50, v50
v_exp_f32 v51, v51
v_cvt_pk_bf16_f32 v72, v48, v49
v_cvt_pk_bf16_f32 v73, v50, v51
v_exp_f32 v52, v52
v_exp_f32 v53, v53
v_exp_f32 v54, v54
v_exp_f32 v55, v55
v_cvt_pk_bf16_f32 v74, v52, v53
v_cvt_pk_bf16_f32 v75, v54, v55
v_mfma_f32_32x32x16_bf16 v[16:31], v[96:99], v[64:67], v[16:31]
v_exp_f32 v56, v56
v_exp_f32 v57, v57
v_exp_f32 v58, v58
v_exp_f32 v59, v59
v_cvt_pk_bf16_f32 v76, v56, v57
v_cvt_pk_bf16_f32 v77, v58, v59
v_mfma_f32_32x32x16_bf16 v[16:31], v[100:103], v[68:71], v[16:31]
v_exp_f32 v60, v60
v_exp_f32 v61, v61
v_exp_f32 v62, v62
v_exp_f32 v63, v63
v_cvt_pk_bf16_f32 v78, v60, v61
v_cvt_pk_bf16_f32 v79, v62, v63
s_waitcnt lgkmcnt(0)
v_mfma_f32_32x32x16_bf16 v[16:31], v[104:107], v[72:75], v[16:31]
v_mfma_f32_32x32x16_bf16 v[16:31], v[108:111], v[76:79], v[16:31]
s_and_b32 s24, s4, 3
s_lshl_b32 s7, s24, 12
s_add_u32 s7, s7, 131072
v_add_u32 v4, s7, v1
s_lshl_b32 s7, s24, 8
s_add_u32 s7, s7, 147968
v_lshlrev_b32 v5, 2, v0
v_add_u32 v5, s7, v5
s_lshl_b32 s7, s6, 2
s_add_u32 s7, s7, s24
s_lshl_b32 s7, s7, 4
s_add_u32 s7, s7, s5
s_lshl_b32 s7, s7, 11
s_add_u32 s25, s7, 10485760
s_cmp_lt_u32 s4, 4
s_cbranch_scc1 gated_mix__softmax_full_mha__ssm_conv_h3__prompt_kernel_fin_lo
v_cmp_le_u32 s[26:27], 32, v0
s_add_u32 s25, s25, 1024
ds_write_b128 v4, v[16:19] offset:2048
ds_write_b128 v4, v[20:23] offset:3072
ds_write_b32 v5, v28
s_waitcnt lgkmcnt(0)
s_barrier
ds_read_b128 v[40:43], v4
ds_read_b128 v[44:47], v4 offset:1024
s_waitcnt lgkmcnt(0)
v_add_f32 v32, v24, v40
v_add_f32 v33, v25, v41
v_add_f32 v34, v26, v42
v_add_f32 v35, v27, v43
v_add_f32 v36, v28, v44
v_add_f32 v37, v29, v45
v_add_f32 v38, v30, v46
v_add_f32 v39, v31, v47
v_mov_b32 v48, v36
s_branch gated_mix__softmax_full_mha__ssm_conv_h3__prompt_kernel_fin_tail
gated_mix__softmax_full_mha__ssm_conv_h3__prompt_kernel_fin_lo:
s_mov_b64 s[26:27], 0
ds_write_b128 v4, v[24:27]
ds_write_b128 v4, v[28:31] offset:1024
s_waitcnt lgkmcnt(0)
s_barrier
ds_read_b128 v[40:43], v4 offset:2048
ds_read_b128 v[44:47], v4 offset:3072
ds_read_b32 v49, v5
s_waitcnt lgkmcnt(0)
v_add_f32 v32, v16, v40
v_add_f32 v33, v17, v41
v_add_f32 v34, v18, v42
v_add_f32 v35, v19, v43
v_add_f32 v36, v20, v44
v_add_f32 v37, v21, v45
v_add_f32 v38, v22, v46
v_add_f32 v39, v23, v47
v_add_f32 v48, v28, v49
gated_mix__softmax_full_mha__ssm_conv_h3__prompt_kernel_fin_tail:
v_mov_b32 v49, v48
v_mov_b32 v50, 0x33800000
v_mov_b32 v51, 0x53800000
v_permlane32_swap_b32 v48, v49
v_mov_b32 v52, 0
v_max3_f32 v52, v52, abs(v32), abs(v33)
v_max3_f32 v52, v52, abs(v34), abs(v35)
v_max3_f32 v52, v52, abs(v36), abs(v37)
v_max3_f32 v52, v52, abs(v38), abs(v39)
v_cmp_ge_f32 vcc, v49, v50
v_cmp_le_f32 s[28:29], v49, v51
v_rcp_f32 v49, v49
v_mov_b32 v51, 0x7f000000
s_and_b64 vcc, vcc, s[28:29]
v_cmp_le_f32 s[28:29], v52, v51
v_mul_f32 v32, v32, v49
v_mul_f32 v33, v33, v49
v_mul_f32 v34, v34, v49
v_mul_f32 v35, v35, v49
v_mul_f32 v36, v36, v49
v_mul_f32 v37, v37, v49
v_mul_f32 v38, v38, v49
v_mul_f32 v39, v39, v49
s_and_b64 vcc, vcc, s[28:29]
v_cndmask_b32 v36, v36, 0, s[26:27]
v_cndmask_b32 v37, v37, 0, s[26:27]
v_cndmask_b32 v38, v38, 0, s[26:27]
v_cndmask_b32 v39, v39, 0, s[26:27]
v_cvt_pk_bf16_f32 v40, v32, v33
v_cvt_pk_bf16_f32 v41, v34, v35
v_cvt_pk_bf16_f32 v42, v36, v37
v_cvt_pk_bf16_f32 v43, v38, v39
s_cmp_eq_u32 s34, 1
s_cbranch_scc1 gated_mix__softmax_full_mha__ssm_conv_h3__prompt_kernel_fin_join
buffer_store_dwordx4 v[40:43], v1, s[16:19], s25 offen sc1
s_cmp_eq_u64 vcc, exec
s_cbranch_scc1 gated_mix__softmax_full_mha__ssm_conv_h3__prompt_kernel_fin_ok
s_cmp_eq_u32 s70, 1
s_cbranch_scc1 gated_mix__softmax_full_mha__ssm_conv_h3__prompt_kernel_fin_ok
v_mov_b32 v50, 147456
v_mov_b32 v51, 1
ds_write_b32 v50, v51
s_waitcnt lgkmcnt(0)
s_branch gated_mix__softmax_full_mha__ssm_conv_h3__prompt_kernel_fin_join
gated_mix__softmax_full_mha__ssm_conv_h3__prompt_kernel_fin_ok:
s_lshl_b32 s69, s6, 2
s_and_b32 s7, s4, 3
s_add_u32 s69, s69, s7
s_lshl_b32 s69, s69, 7
s_lshl_b32 s7, s5, 1
s_lshr_b32 s28, s4, 2
s_add_u32 s7, s7, s28
s_lshl_b32 s7, s7, 2
s_add_u32 s69, s69, s7
s_add_u32 s69, s69, 14700544
s_waitcnt vmcnt(0)
v_mov_b32 v250, s64
v_lshlrev_b32 v251, 7, v0
s_mov_b64 s[66:67], exec
s_mov_b64 exec, 1
buffer_store_dword v250, v251, s[16:19], s69 offen sc1
s_mov_b64 exec, s[66:67]
s_mov_b32 s34, 1
gated_mix__softmax_full_mha__ssm_conv_h3__prompt_kernel_fin_join:
s_barrier
v_mov_b32 v50, 147456
ds_read_b32 v51, v50
s_waitcnt lgkmcnt(0)
v_readfirstlane_b32 s7, v51
s_cmp_eq_u32 s7, 0
s_cbranch_scc1 gated_mix__softmax_full_mha__ssm_conv_h3__prompt_kernel_attn_done
s_cmp_eq_u32 s70, 1
s_cbranch_scc1 gated_mix__softmax_full_mha__ssm_conv_h3__prompt_kernel_attn_done
gated_mix__softmax_full_mha__ssm_conv_h3__prompt_kernel_fallback:
s_mov_b32 s70, 1
s_lshl_b32 s20, s5, 6
s_lshr_b32 s7, s4, 2
s_lshl_b32 s7, s7, 5
s_add_u32 s20, s20, s7
s_and_b32 s7, s4, 3
s_add_u32 s20, s20, s7
s_lshl_b32 s20, s20, 12
s_add_u32 s20, s20, 2097152
s_lshl_b32 s21, s4, 12
s_lshr_b32 s7, s4, 2
s_lshl_b32 s7, s7, 14
v_add_u32 v2, s7, v1
v_mov_b32 v4, 0xff800000
s_waitcnt vmcnt(0)
s_mov_b32 s23, 8
gated_mix__softmax_full_mha__ssm_conv_h3__prompt_kernel_mloop:
s_barrier
s_mov_b32 m0, s21
s_nop 0
buffer_load_dwordx4 v1, s[16:19], s20 offen offset:0 sc1 lds
buffer_load_dwordx4 v1, s[16:19], s20 offen offset:1024 sc1 lds
buffer_load_dwordx4 v1, s[16:19], s20 offen offset:2048 sc1 lds
buffer_load_dwordx4 v1, s[16:19], s20 offen offset:3072 sc1 lds
s_add_u32 s20, s20, 16384
s_waitcnt vmcnt(0)
s_barrier
ds_read_b128 v[80:83], v2 offset:0
ds_read_b128 v[84:87], v2 offset:1024
s_waitcnt lgkmcnt(0)
v_mfma_f32_32x32x16_bf16 v[32:47], v[80:83], v[8:11], 0
v_mfma_f32_32x32x16_bf16 v[32:47], v[84:87], v[12:15], v[32:47]
s_nop 11
v_max3_f32 v4, v4, v32, v33
v_max3_f32 v4, v4, v34, v35
v_max3_f32 v4, v4, v36, v37
v_max3_f32 v4, v4, v38, v39
v_max3_f32 v4, v4, v40, v41
v_max3_f32 v4, v4, v42, v43
v_max3_f32 v4, v4, v44, v45
v_max3_f32 v4, v4, v46, v47
ds_read_b128 v[80:83], v2 offset:4096
ds_read_b128 v[84:87], v2 offset:5120
s_waitcnt lgkmcnt(0)
v_mfma_f32_32x32x16_bf16 v[32:47], v[80:83], v[8:11], 0
v_mfma_f32_32x32x16_bf16 v[32:47], v[84:87], v[12:15], v[32:47]
s_nop 11
v_max3_f32 v4, v4, v32, v33
v_max3_f32 v4, v4, v34, v35
v_max3_f32 v4, v4, v36, v37
v_max3_f32 v4, v4, v38, v39
v_max3_f32 v4, v4, v40, v41
v_max3_f32 v4, v4, v42, v43
v_max3_f32 v4, v4, v44, v45
v_max3_f32 v4, v4, v46, v47
ds_read_b128 v[80:83], v2 offset:8192
ds_read_b128 v[84:87], v2 offset:9216
s_waitcnt lgkmcnt(0)
v_mfma_f32_32x32x16_bf16 v[32:47], v[80:83], v[8:11], 0
v_mfma_f32_32x32x16_bf16 v[32:47], v[84:87], v[12:15], v[32:47]
s_nop 11
v_max3_f32 v4, v4, v32, v33
v_max3_f32 v4, v4, v34, v35
v_max3_f32 v4, v4, v36, v37
v_max3_f32 v4, v4, v38, v39
v_max3_f32 v4, v4, v40, v41
v_max3_f32 v4, v4, v42, v43
v_max3_f32 v4, v4, v44, v45
v_max3_f32 v4, v4, v46, v47
ds_read_b128 v[80:83], v2 offset:12288
ds_read_b128 v[84:87], v2 offset:13312
s_waitcnt lgkmcnt(0)
v_mfma_f32_32x32x16_bf16 v[32:47], v[80:83], v[8:11], 0
v_mfma_f32_32x32x16_bf16 v[32:47], v[84:87], v[12:15], v[32:47]
s_nop 11
v_max3_f32 v4, v4, v32, v33
v_max3_f32 v4, v4, v34, v35
v_max3_f32 v4, v4, v36, v37
v_max3_f32 v4, v4, v38, v39
v_max3_f32 v4, v4, v40, v41
v_max3_f32 v4, v4, v42, v43
v_max3_f32 v4, v4, v44, v45
v_max3_f32 v4, v4, v46, v47
s_sub_u32 s23, s23, 1
s_cmp_lg_u32 s23, 0
s_cbranch_scc1 gated_mix__softmax_full_mha__ssm_conv_h3__prompt_kernel_mloop
v_mov_b32 v5, v4
s_nop 1
v_permlane32_swap_b32 v4, v5
s_nop 1
v_max_f32 v4, v4, v5
s_lshl_b32 s7, s4, 8
s_add_u32 s7, s7, 131072
v_lshlrev_b32 v5, 2, v0
v_add_u32 v6, s7, v5
ds_write_b32 v6, v4
s_xor_b32 s7, s4, 4
s_lshl_b32 s7, s7, 8
s_add_u32 s7, s7, 131072
v_add_u32 v6, s7, v5
s_waitcnt lgkmcnt(0)
s_barrier
ds_read_b32 v5, v6
v_mov_b32 v50, 147456
v_mov_b32 v51, 0
s_waitcnt lgkmcnt(0)
v_max_f32 v4, v4, v5
s_barrier
ds_write_b32 v50, v51
v_and_b32 v5, 0xffff0000, v4
v_sub_f32 v6, v4, v5
v_and_b32 v7, 0xffff0000, v6
v_sub_f32 v6, v6, v7
v_xor_b32 v5, 0x80000000, v5
v_xor_b32 v7, 0x80000000, v7
v_xor_b32 v6, 0x80000000, v6
v_lshrrev_b32 v5, 16, v5
v_or_b32 v5, v5, v7
v_lshrrev_b32 v6, 16, v6
v_cmp_gt_u32 vcc, 32, v0
s_nop 1
v_cndmask_b32 v14, v5, v14, vcc
v_cndmask_b32 v15, v6, v15, vcc
s_waitcnt lgkmcnt(0)
s_barrier
s_branch gated_mix__softmax_full_mha__ssm_conv_h3__prompt_kernel_attn_redo
gated_mix__softmax_full_mha__ssm_conv_h3__prompt_kernel_cslow0:
s_mov_b32 s68, 200000
csl_30:
ds_read_b32 v115, v114 offset:4
s_sub_u32 s68, s68, 1
s_waitcnt lgkmcnt(0)
v_readfirstlane_b32 s7, v115
s_cmp_eq_u32 s68, 0
s_cbranch_scc1 gated_mix__softmax_full_mha__ssm_conv_h3__prompt_kernel_cret0
s_cmp_ge_u32 s7, s22
s_cbranch_scc0 csl_30
s_branch gated_mix__softmax_full_mha__ssm_conv_h3__prompt_kernel_cret0
gated_mix__softmax_full_mha__ssm_conv_h3__prompt_kernel_cslow1:
s_mov_b32 s68, 200000
csl_31:
ds_read_b32 v115, v114 offset:8
s_sub_u32 s68, s68, 1
s_waitcnt lgkmcnt(0)
v_readfirstlane_b32 s7, v115
s_cmp_eq_u32 s68, 0
s_cbranch_scc1 gated_mix__softmax_full_mha__ssm_conv_h3__prompt_kernel_cret1
s_cmp_ge_u32 s7, s22
s_cbranch_scc0 csl_31
s_branch gated_mix__softmax_full_mha__ssm_conv_h3__prompt_kernel_cret1
gated_mix__softmax_full_mha__ssm_conv_h3__prompt_kernel_cslow2:
s_mov_b32 s68, 200000
csl_32:
ds_read_b32 v115, v114 offset:12
s_sub_u32 s68, s68, 1
s_waitcnt lgkmcnt(0)
v_readfirstlane_b32 s7, v115
s_cmp_eq_u32 s68, 0
s_cbranch_scc1 gated_mix__softmax_full_mha__ssm_conv_h3__prompt_kernel_cret2
s_cmp_ge_u32 s7, s22
s_cbranch_scc0 csl_32
s_branch gated_mix__softmax_full_mha__ssm_conv_h3__prompt_kernel_cret2
gated_mix__softmax_full_mha__ssm_conv_h3__prompt_kernel_cslow3:
s_mov_b32 s68, 200000
csl_33:
ds_read_b32 v115, v114 offset:16
s_sub_u32 s68, s68, 1
s_waitcnt lgkmcnt(0)
v_readfirstlane_b32 s7, v115
s_cmp_eq_u32 s68, 0
s_cbranch_scc1 gated_mix__softmax_full_mha__ssm_conv_h3__prompt_kernel_cret3
s_cmp_ge_u32 s7, s22
s_cbranch_scc0 csl_33
s_branch gated_mix__softmax_full_mha__ssm_conv_h3__prompt_kernel_cret3
gated_mix__softmax_full_mha__ssm_conv_h3__prompt_kernel_cslow4:
s_mov_b32 s68, 200000
csl_34:
ds_read_b32 v115, v114 offset:20
s_sub_u32 s68, s68, 1
s_waitcnt lgkmcnt(0)
v_readfirstlane_b32 s7, v115
s_cmp_eq_u32 s68, 0
s_cbranch_scc1 gated_mix__softmax_full_mha__ssm_conv_h3__prompt_kernel_cret4
s_cmp_ge_u32 s7, s22
s_cbranch_scc0 csl_34
s_branch gated_mix__softmax_full_mha__ssm_conv_h3__prompt_kernel_cret4
gated_mix__softmax_full_mha__ssm_conv_h3__prompt_kernel_cslow5:
s_mov_b32 s68, 200000
csl_35:
ds_read_b32 v115, v114 offset:24
s_sub_u32 s68, s68, 1
s_waitcnt lgkmcnt(0)
v_readfirstlane_b32 s7, v115
s_cmp_eq_u32 s68, 0
s_cbranch_scc1 gated_mix__softmax_full_mha__ssm_conv_h3__prompt_kernel_cret5
s_cmp_ge_u32 s7, s22
s_cbranch_scc0 csl_35
s_branch gated_mix__softmax_full_mha__ssm_conv_h3__prompt_kernel_cret5
gated_mix__softmax_full_mha__ssm_conv_h3__prompt_kernel_cslow6:
s_mov_b32 s68, 200000
csl_36:
ds_read_b32 v115, v114 offset:28
s_sub_u32 s68, s68, 1
s_waitcnt lgkmcnt(0)
v_readfirstlane_b32 s7, v115
s_cmp_eq_u32 s68, 0
s_cbranch_scc1 gated_mix__softmax_full_mha__ssm_conv_h3__prompt_kernel_cret6
s_cmp_ge_u32 s7, s22
s_cbranch_scc0 csl_36
s_branch gated_mix__softmax_full_mha__ssm_conv_h3__prompt_kernel_cret6
gated_mix__softmax_full_mha__ssm_conv_h3__prompt_kernel_cslow7:
s_mov_b32 s68, 200000
csl_37:
ds_read_b32 v115, v114 offset:32
s_sub_u32 s68, s68, 1
s_waitcnt lgkmcnt(0)
v_readfirstlane_b32 s7, v115
s_cmp_eq_u32 s68, 0
s_cbranch_scc1 gated_mix__softmax_full_mha__ssm_conv_h3__prompt_kernel_cret7
s_cmp_ge_u32 s7, s22
s_cbranch_scc0 csl_37
s_branch gated_mix__softmax_full_mha__ssm_conv_h3__prompt_kernel_cret7
gated_mix__softmax_full_mha__ssm_conv_h3__prompt_kernel_attn_redo:
s_lshl_b32 s20, s5, 6
s_lshr_b32 s7, s4, 2
s_lshl_b32 s7, s7, 5
s_add_u32 s20, s20, s7
s_and_b32 s7, s4, 3
s_add_u32 s20, s20, s7
s_lshl_b32 s20, s20, 12
s_add_u32 s20, s20, 2097152
s_lshl_b32 s21, s4, 12
s_and_b32 s99, s6, 7
s_lshl_b32 s7, s99, 14
s_add_u32 s20, s20, s7
s_mov_b32 m0, s21
s_nop 0
buffer_load_dwordx4 v1, s[16:19], s20 offen offset:0 sc1 lds
buffer_load_dwordx4 v1, s[16:19], s20 offen offset:1024 sc1 lds
buffer_load_dwordx4 v1, s[16:19], s20 offen offset:2048 sc1 lds
buffer_load_dwordx4 v1, s[16:19], s20 offen offset:3072 sc1 lds
s_add_u32 s99, s99, 1
s_cmp_eq_u32 s99, 8
s_cselect_b32 s7, 0x20000, 0
s_sub_u32 s20, s20, s7
s_and_b32 s99, s99, 7
s_add_u32 s20, s20, 16384
s_add_u32 s21, s21, 32768
s_mov_b32 m0, s21
s_nop 0
buffer_load_dwordx4 v1, s[16:19], s20 offen offset:0 sc1 lds
buffer_load_dwordx4 v1, s[16:19], s20 offen offset:1024 sc1 lds
buffer_load_dwordx4 v1, s[16:19], s20 offen offset:2048 sc1 lds
buffer_load_dwordx4 v1, s[16:19], s20 offen offset:3072 sc1 lds
s_add_u32 s99, s99, 1
s_cmp_eq_u32 s99, 8
s_cselect_b32 s7, 0x20000, 0
s_sub_u32 s20, s20, s7
s_and_b32 s99, s99, 7
s_add_u32 s20, s20, 16384
s_add_u32 s21, s21, 32768
s_waitcnt vmcnt(4)
s_barrier
s_mov_b32 m0, s21
s_nop 0
buffer_load_dwordx4 v1, s[16:19], s20 offen offset:0 sc1 lds
buffer_load_dwordx4 v1, s[16:19], s20 offen offset:1024 sc1 lds
buffer_load_dwordx4 v1, s[16:19], s20 offen offset:2048 sc1 lds
buffer_load_dwordx4 v1, s[16:19], s20 offen offset:3072 sc1 lds
s_add_u32 s99, s99, 1
s_cmp_eq_u32 s99, 8
s_cselect_b32 s7, 0x20000, 0
s_sub_u32 s20, s20, s7
s_and_b32 s99, s99, 7
s_add_u32 s20, s20, 16384
s_add_u32 s21, s21, 32768
s_branch gated_mix__softmax_full_mha__ssm_conv_h3__prompt_kernel_attn_go
gated_mix__softmax_full_mha__ssm_conv_h3__prompt_kernel_attn_done:
s_setprio 0
s_and_b32 s5, s2, 7
s_lshl_b32 s5, s5, 3
s_bfe_u32 s6, s2, 0x30003
s_add_u32 s5, s5, s6
s_lshr_b32 s6, s2, 6
s_mov_b64 s[12:13], s[36:37]
s_mov_b32 s14, 0x1c0000
s_mov_b32 s15, 0x20000
s_mov_b64 s[24:25], s[56:57]
s_mov_b32 s26, 0x1c0000
s_mov_b32 s27, 0x20000
s_lshl_b32 s28, s4, 1
s_add_u32 s28, s28, 96
s_mul_i32 s30, s28, 3584
s_add_u32 s30, s30, s96
s_lshl_b32 m0, s28, 10
s_nop 0
buffer_load_dwordx4 v180, s[8:11], s30 offen lds
s_add_u32 s30, s30, 3584
s_add_u32 m0, m0, 1024
s_nop 0
buffer_load_dwordx4 v180, s[8:11], s30 offen lds
s_mul_i32 s63, s6, 448
s_add_u32 s63, s63, 14696448
v_lshlrev_b32 v253, 2, v0
v_min_u32 v254, 47, v0
v_lshlrev_b32 v254, 2, v254
v_add_u32 v254, 256, v254
v_mov_b32 v255, v254
buffer_load_dword v252, v253, s[16:19], s63 offen sc1
buffer_load_dword v254, v255, s[16:19], s63 offen sc1
s_and_b32 s21, s4, 3
s_lshr_b32 s22, s4, 2
v_and_b32 v3, 31, v0
s_lshl_b32 s29, s5, 5
v_add_u32 v3, s29, v3
v_lshrrev_b32 v4, 5, v0
s_lshl_b32 s29, s21, 5
s_lshl_b32 s30, s22, 3
s_add_u32 s29, s29, s30
v_lshlrev_b32 v5, 4, v4
v_add_u32 v5, s29, v5
v_cmp_gt_u32 vcc, 112, v5
s_mul_i32 s29, s6, 112
s_mov_b64 s[32:33], vcc
v_add_u32 v5, s29, v5
v_mul_u32_u24 v6, 896, v3
v_lshl_add_u32 v6, v5, 1, v6
v_lshlrev_b32 v7, 12, v5
v_lshl_add_u32 v7, v3, 1, v7
v_lshlrev_b32 v8, 2, v3
v_bfe_u32 v9, v0, 2, 2
v_lshlrev_b32 v9, 6, v9
v_lshl_add_u32 v9, v4, 10, v9
v_and_b32 v10, 1, v0
v_lshl_add_u32 v9, v10, 5, v9
v_bfe_u32 v10, v0, 1, 1
v_lshl_add_u32 v9, v10, 3, v9
v_bfe_u32 v10, v0, 4, 1
v_lshl_add_u32 v9, v10, 4, v9
s_lshl_b32 s29, s21, 8
s_mul_i32 s30, s22, 57344
s_add_u32 s29, s29, s30
v_add_u32 v9, s29, v9
s_lshl_b32 s29, s22, 14
s_add_u32 s29, s29, 114688
v_add_u32 v10, s29, v1
s_cmp_lg_u32 s2, 0
s_cbranch_scc1 ep_38
s_cmp_lg_u32 s4, 6
s_cbranch_scc1 ep_38
s_mov_b64 s[28:29], s[58:59]
s_mov_b32 s30, 0x100
s_mov_b32 s31, 0x20000
v_mov_b32 v250, 0
s_mov_b32 s68, 40000
epl_39:
buffer_load_dword v251, v250, s[28:31], 0 offen sc1
s_sub_u32 s68, s68, 1
s_waitcnt vmcnt(0)
v_readfirstlane_b32 s66, v251
s_cmp_eq_u32 s68, 0
s_cbranch_scc1 ep_38
s_cmp_lt_u32 s66, 256
s_cbranch_scc1 epl_39
v_mov_b32 v251, s64
s_mov_b32 s66, 14680064
s_mov_b64 s[62:63], exec
s_mov_b64 exec, 1
buffer_store_dword v251, v250, s[16:19], s66 offen sc1
s_mov_b64 exec, s[62:63]
ep_38:
s_waitcnt vmcnt(0)
v_cmp_ne_u32 vcc, s64, v252
v_cmp_ne_u32 s[66:67], s64, v254
s_or_b64 vcc, vcc, s[66:67]
s_nop 1
s_cbranch_vccz fyok_40
s_mul_i32 s63, s6, 448
s_add_u32 s63, s63, 14696448
s_mov_b32 s68, 40000
fyp_41:
buffer_load_dword v252, v253, s[16:19], s63 offen sc1
buffer_load_dword v254, v255, s[16:19], s63 offen sc1
s_sub_u32 s68, s68, 1
s_waitcnt vmcnt(0)
v_cmp_ne_u32 vcc, s64, v252
v_cmp_ne_u32 s[66:67], s64, v254
s_or_b64 vcc, vcc, s[66:67]
s_cmp_eq_u32 s68, 0
s_cbranch_scc1 fyd_42
s_cbranch_vccnz fyp_41
fyd_42:
fyok_40:
s_barrier
ds_read_b64_tr_b16 v[184:185], v9 offset:0
ds_read_b64_tr_b16 v[186:187], v9 offset:2048
ds_read_b64_tr_b16 v[188:189], v9 offset:4096
ds_read_b64_tr_b16 v[190:191], v9 offset:6144
ds_read_b64_tr_b16 v[192:193], v9 offset:7168
ds_read_b64_tr_b16 v[194:195], v9 offset:9216
ds_read_b64_tr_b16 v[196:197], v9 offset:11264
ds_read_b64_tr_b16 v[198:199], v9 offset:13312
ds_read_b64_tr_b16 v[200:201], v9 offset:14336
ds_read_b64_tr_b16 v[202:203], v9 offset:16384
ds_read_b64_tr_b16 v[204:205], v9 offset:18432
ds_read_b64_tr_b16 v[206:207], v9 offset:20480
ds_read_b64_tr_b16 v[208:209], v9 offset:21504
ds_read_b64_tr_b16 v[210:211], v9 offset:23552
ds_read_b64_tr_b16 v[212:213], v9 offset:25600
ds_read_b64_tr_b16 v[214:215], v9 offset:27648
ds_read_b64_tr_b16 v[216:217], v9 offset:28672
ds_read_b64_tr_b16 v[218:219], v9 offset:30720
ds_read_b64_tr_b16 v[220:221], v9 offset:32768
ds_read_b64_tr_b16 v[222:223], v9 offset:34816
ds_read_b64_tr_b16 v[224:225], v9 offset:35840
ds_read_b64_tr_b16 v[226:227], v9 offset:37888
ds_read_b64_tr_b16 v[228:229], v9 offset:39936
ds_read_b64_tr_b16 v[230:231], v9 offset:41984
ds_read_b64_tr_b16 v[232:233], v9 offset:43008
ds_read_b64_tr_b16 v[234:235], v9 offset:45056
ds_read_b64_tr_b16 v[236:237], v9 offset:47104
ds_read_b64_tr_b16 v[238:239], v9 offset:49152
ds_read_b64_tr_b16 v[240:241], v9 offset:50176
ds_read_b64_tr_b16 v[242:243], v9 offset:52224
ds_read_b64_tr_b16 v[244:245], v9 offset:54272
ds_read_b64_tr_b16 v[246:247], v9 offset:56320
v_mov_b32 v40, 0
v_mov_b32 v41, 0
v_mov_b32 v42, 0
v_mov_b32 v43, 0
v_mov_b32 v44, 0
v_mov_b32 v45, 0
v_mov_b32 v46, 0
v_mov_b32 v47, 0
buffer_load_dwordx4 v[36:39], v6, s[12:15], 0 offen
s_mov_b32 s29, 8388608
buffer_load_short_d16_hi v40, v7, s[16:19], s29 offen sc1
s_add_u32 s29, s29, 4096
buffer_load_short_d16_hi v41, v7, s[16:19], s29 offen sc1
s_add_u32 s29, s29, 4096
buffer_load_short_d16_hi v42, v7, s[16:19], s29 offen sc1
s_add_u32 s29, s29, 4096
buffer_load_short_d16_hi v43, v7, s[16:19], s29 offen sc1
s_add_u32 s29, s29, 4096
buffer_load_short_d16_hi v44, v7, s[16:19], s29 offen sc1
s_add_u32 s29, s29, 4096
buffer_load_short_d16_hi v45, v7, s[16:19], s29 offen sc1
s_add_u32 s29, s29, 4096
buffer_load_short_d16_hi v46, v7, s[16:19], s29 offen sc1
s_add_u32 s29, s29, 4096
buffer_load_short_d16_hi v47, v7, s[16:19], s29 offen sc1
s_cmp_lg_u32 s4, 7
s_cbranch_scc1 nof_43
s_lshl_b32 s63, s5, 7
s_add_u32 s63, s63, 14700544
v_and_b32 v253, 31, v0
v_lshlrev_b32 v253, 2, v253
s_mov_b32 s68, 40000
sp_44:
buffer_load_dword v252, v253, s[16:19], s63 offen sc1
s_sub_u32 s68, s68, 1
s_waitcnt vmcnt(0)
v_cmp_ne_u32 vcc, s64, v252
s_cmp_eq_u32 s68, 0
s_cbranch_scc1 sd_45
s_cbranch_vccnz sp_44
sd_45:
s_lshl_b32 s28, s5, 15
s_add_u32 s28, s28, 10485760
s_mov_b32 m0, 114688
s_nop 0
buffer_load_dwordx4 v1, s[16:19], s28 offen offset:0 sc1 lds
buffer_load_dwordx4 v1, s[16:19], s28 offen offset:1024 sc1 lds
buffer_load_dwordx4 v1, s[16:19], s28 offen offset:2048 sc1 lds
buffer_load_dwordx4 v1, s[16:19], s28 offen offset:3072 sc1 lds
s_mov_b32 m0, 118784
s_add_u32 s28, s28, 4096
buffer_load_dwordx4 v1, s[16:19], s28 offen offset:0 sc1 lds
buffer_load_dwordx4 v1, s[16:19], s28 offen offset:1024 sc1 lds
buffer_load_dwordx4 v1, s[16:19], s28 offen offset:2048 sc1 lds
buffer_load_dwordx4 v1, s[16:19], s28 offen offset:3072 sc1 lds
s_mov_b32 m0, 122880
s_add_u32 s28, s28, 4096
buffer_load_dwordx4 v1, s[16:19], s28 offen offset:0 sc1 lds
buffer_load_dwordx4 v1, s[16:19], s28 offen offset:1024 sc1 lds
buffer_load_dwordx4 v1, s[16:19], s28 offen offset:2048 sc1 lds
buffer_load_dwordx4 v1, s[16:19], s28 offen offset:3072 sc1 lds
s_mov_b32 m0, 126976
s_add_u32 s28, s28, 4096
buffer_load_dwordx4 v1, s[16:19], s28 offen offset:0 sc1 lds
buffer_load_dwordx4 v1, s[16:19], s28 offen offset:1024 sc1 lds
buffer_load_dwordx4 v1, s[16:19], s28 offen offset:2048 sc1 lds
buffer_load_dwordx4 v1, s[16:19], s28 offen offset:3072 sc1 lds
s_mov_b32 m0, 131072
s_add_u32 s28, s28, 4096
buffer_load_dwordx4 v1, s[16:19], s28 offen offset:0 sc1 lds
buffer_load_dwordx4 v1, s[16:19], s28 offen offset:1024 sc1 lds
buffer_load_dwordx4 v1, s[16:19], s28 offen offset:2048 sc1 lds
buffer_load_dwordx4 v1, s[16:19], s28 offen offset:3072 sc1 lds
s_mov_b32 m0, 135168
s_add_u32 s28, s28, 4096
buffer_load_dwordx4 v1, s[16:19], s28 offen offset:0 sc1 lds
buffer_load_dwordx4 v1, s[16:19], s28 offen offset:1024 sc1 lds
buffer_load_dwordx4 v1, s[16:19], s28 offen offset:2048 sc1 lds
buffer_load_dwordx4 v1, s[16:19], s28 offen offset:3072 sc1 lds
s_mov_b32 m0, 139264
s_add_u32 s28, s28, 4096
buffer_load_dwordx4 v1, s[16:19], s28 offen offset:0 sc1 lds
buffer_load_dwordx4 v1, s[16:19], s28 offen offset:1024 sc1 lds
buffer_load_dwordx4 v1, s[16:19], s28 offen offset:2048 sc1 lds
buffer_load_dwordx4 v1, s[16:19], s28 offen offset:3072 sc1 lds
s_mov_b32 m0, 143360
s_add_u32 s28, s28, 4096
buffer_load_dwordx4 v1, s[16:19], s28 offen offset:0 sc1 lds
buffer_load_dwordx4 v1, s[16:19], s28 offen offset:1024 sc1 lds
buffer_load_dwordx4 v1, s[16:19], s28 offen offset:2048 sc1 lds
buffer_load_dwordx4 v1, s[16:19], s28 offen offset:3072 sc1 lds
nof_43:
s_waitcnt vmcnt(0) lgkmcnt(0)
v_cmp_gt_u32 vcc, 32, v0
s_nop 1
v_cndmask_b32 v246, 0, v246, vcc
v_cndmask_b32 v247, 0, v247, vcc
s_barrier
v_mov_b32 v48, v113
ds_read_b128 v[116:119], v10 offset:0
ds_read_b128 v[120:123], v10 offset:1024
ds_read_b128 v[124:127], v10 offset:2048
ds_read_b128 v[128:131], v10 offset:3072
ds_read_b128 v[132:135], v10 offset:4096
ds_read_b128 v[136:139], v10 offset:5120
ds_read_b128 v[140:143], v10 offset:6144
ds_read_b128 v[144:147], v10 offset:7168
ds_read_b128 v[148:151], v10 offset:8192
ds_read_b128 v[152:155], v10 offset:9216
ds_read_b128 v[156:159], v10 offset:10240
ds_read_b128 v[160:163], v10 offset:11264
ds_read_b128 v[164:167], v10 offset:12288
ds_read_b128 v[168:171], v10 offset:13312
ds_read_b128 v[172:175], v10 offset:14336
ds_read_b128 v[176:179], v10 offset:15360
s_waitcnt lgkmcnt(14)
v_mfma_f32_32x32x16_bf16 v[16:31], v[184:187], v[116:119], 0
v_mfma_f32_32x32x16_bf16 v[16:31], v[188:191], v[120:123], v[16:31]
s_waitcnt lgkmcnt(12)
v_mfma_f32_32x32x16_bf16 v[16:31], v[192:195], v[124:127], v[16:31]
v_mfma_f32_32x32x16_bf16 v[16:31], v[196:199], v[128:131], v[16:31]
s_waitcnt lgkmcnt(10)
v_mfma_f32_32x32x16_bf16 v[16:31], v[200:203], v[132:135], v[16:31]
v_mfma_f32_32x32x16_bf16 v[16:31], v[204:207], v[136:139], v[16:31]
s_waitcnt lgkmcnt(8)
v_mfma_f32_32x32x16_bf16 v[16:31], v[208:211], v[140:143], v[16:31]
v_mfma_f32_32x32x16_bf16 v[16:31], v[212:215], v[144:147], v[16:31]
s_waitcnt lgkmcnt(6)
v_mfma_f32_32x32x16_bf16 v[16:31], v[216:219], v[148:151], v[16:31]
v_mfma_f32_32x32x16_bf16 v[16:31], v[220:223], v[152:155], v[16:31]
s_waitcnt lgkmcnt(4)
v_mfma_f32_32x32x16_bf16 v[16:31], v[224:227], v[156:159], v[16:31]
v_mfma_f32_32x32x16_bf16 v[16:31], v[228:231], v[160:163], v[16:31]
s_waitcnt lgkmcnt(2)
v_mfma_f32_32x32x16_bf16 v[16:31], v[232:235], v[164:167], v[16:31]
v_mfma_f32_32x32x16_bf16 v[16:31], v[236:239], v[168:171], v[16:31]
s_waitcnt lgkmcnt(0)
v_mfma_f32_32x32x16_bf16 v[16:31], v[240:243], v[172:175], v[16:31]
v_mfma_f32_32x32x16_bf16 v[16:31], v[244:247], v[176:179], v[16:31]
s_lshl_b32 s29, s4, 11
s_add_u32 s29, s29, 147456
v_add_u32 v10, s29, v1
s_xor_b32 s29, s4, 4
s_lshl_b32 s29, s29, 11
s_add_u32 s29, s29, 147456
v_add_u32 v11, s29, v1
s_waitcnt vmcnt(0)
v_sub_f32 v49, 1.0, v48
v_cvt_pk_bf16_f32 v49, v49, v49
v_and_b32 v49, 0xffff0000, v49
v_lshlrev_b32 v50, 16, v36
v_mul_f32 v40, v40, v50
v_mul_f32 v40, v40, v49
v_and_b32 v50, 0xffff0000, v36
v_mul_f32 v41, v41, v50
v_mul_f32 v41, v41, v49
v_lshlrev_b32 v50, 16, v37
v_mul_f32 v42, v42, v50
v_mul_f32 v42, v42, v49
v_and_b32 v50, 0xffff0000, v37
v_mul_f32 v43, v43, v50
v_mul_f32 v43, v43, v49
v_lshlrev_b32 v50, 16, v38
v_mul_f32 v44, v44, v50
v_mul_f32 v44, v44, v49
v_and_b32 v50, 0xffff0000, v38
v_mul_f32 v45, v45, v50
v_mul_f32 v45, v45, v49
v_lshlrev_b32 v50, 16, v39
v_mul_f32 v46, v46, v50
v_mul_f32 v46, v46, v49
v_and_b32 v50, 0xffff0000, v39
v_mul_f32 v47, v47, v50
v_mul_f32 v47, v47, v49
s_cmp_eq_u32 s22, 1
s_cbranch_scc1 gated_mix__softmax_full_mha__ssm_conv_h3__prompt_kernel_kh1
ds_write_b128 v10, v[24:27]
ds_write_b128 v10, v[28:31] offset:1024
s_branch gated_mix__softmax_full_mha__ssm_conv_h3__prompt_kernel_khj
gated_mix__softmax_full_mha__ssm_conv_h3__prompt_kernel_kh1:
ds_write_b128 v10, v[16:19]
ds_write_b128 v10, v[20:23] offset:1024
v_mov_b32 v16, v24
v_mov_b32 v17, v25
v_mov_b32 v18, v26
v_mov_b32 v19, v27
v_mov_b32 v20, v28
v_mov_b32 v21, v29
v_mov_b32 v22, v30
v_mov_b32 v23, v31
gated_mix__softmax_full_mha__ssm_conv_h3__prompt_kernel_khj:
s_waitcnt lgkmcnt(0)
s_barrier
ds_read_b128 v[64:67], v11
ds_read_b128 v[68:71], v11 offset:1024
s_waitcnt lgkmcnt(0)
v_add_f32 v16, v16, v64
v_fmac_f32 v40, v48, v16
v_add_f32 v17, v17, v65
v_fmac_f32 v41, v48, v17
v_add_f32 v18, v18, v66
v_fmac_f32 v42, v48, v18
v_add_f32 v19, v19, v67
v_fmac_f32 v43, v48, v19
v_add_f32 v20, v20, v68
v_fmac_f32 v44, v48, v20
v_add_f32 v21, v21, v69
v_fmac_f32 v45, v48, v21
v_add_f32 v22, v22, v70
v_fmac_f32 v46, v48, v22
v_add_f32 v23, v23, v71
v_fmac_f32 v47, v48, v23
v_cvt_pk_bf16_f32 v72, v40, v41
v_cvt_pk_bf16_f32 v73, v42, v43
v_cvt_pk_bf16_f32 v74, v44, v45
v_cvt_pk_bf16_f32 v75, v46, v47
s_and_saveexec_b64 s[34:35], s[32:33]
s_cbranch_execz nost_46
buffer_store_dwordx4 v[72:75], v6, s[24:27], 0 offen
nost_46:
s_mov_b64 exec, s[34:35]
gated_mix__softmax_full_mha__ssm_conv_h3__prompt_kernel_end:
s_endpgm
.section .rodata,"a"
.p2align 6
.amdhsa_kernel gated_mix__softmax_full_mha__ssm_conv_h3__prompt_kernel
  .amdhsa_next_free_vgpr 256
  .amdhsa_next_free_sgpr 100
  .amdhsa_accum_offset 256
  .amdhsa_group_segment_fixed_size 0
  .amdhsa_kernarg_size 104
  .amdhsa_user_sgpr_count 2
  .amdhsa_user_sgpr_kernarg_segment_ptr 1
  .amdhsa_system_sgpr_workgroup_id_x 1
  .amdhsa_float_denorm_mode_32 3
.end_amdhsa_kernel
```
